```python
import torch

def _softmax(x, axis=-1):
    return torch.softmax(x, dim=axis)
def _gelu(x):
    return torch.nn.functional.gelu(x, approximate="tanh")
def _silu(x):
    return torch.nn.functional.silu(x)
def _sigmoid(x):
    return torch.sigmoid(x)
def _layernorm(x, axis=-1, eps=1e-5):
    m = x.mean(dim=axis, keepdim=True)
    v = x.var(dim=axis, keepdim=True, unbiased=False)
    return (x - m) / torch.sqrt(v + eps)
def _scatter_add(tgt, idx, src, axis=0):
    return tgt.clone().index_add_(axis, idx, src)
def _segment_sum(src, seg, n):
    out = torch.zeros((n,) + src.shape[1:], dtype=src.dtype)
    return out.index_add_(0, seg, src)
def _pad(x, pw):
    flat = tuple(v for pair in reversed(pw) for v in pair)
    return torch.nn.functional.pad(x, flat)

kernel_name = 'standalone__batchnorm__prompt'

def setup_inputs():

    _w = (lambda a: (lambda t: t.to(torch.bfloat16) if t.is_floating_point() else t)(torch.as_tensor(a)))
    B, S, C = 2, 2048, 576
    K = 3
    return {
        "x": _w((lambda *s: torch.randn(*s, dtype=torch.bfloat16) * 0.05)(B, S, C)),
        "w": _w((lambda *s: torch.randn(*s, dtype=torch.bfloat16) * 0.05)(K, C, C) * (1.0 / (K * C) ** 0.5)),
        "mean": _w((lambda *s: torch.randn(*s, dtype=torch.bfloat16) * 0.05)(C) * 0.1),
        "var": _w(torch.abs((lambda *s: torch.randn(*s, dtype=torch.bfloat16) * 0.05)(C)) + 0.5),
        "g": _w((lambda *s: torch.randn(*s, dtype=torch.bfloat16) * 0.05)(C) + 1.0),
        "b": _w((lambda *s: torch.randn(*s, dtype=torch.bfloat16) * 0.05)(C) * 0.1),
    }

def reference(x, w, mean, var, g, b):
    K = 3
    P = K // 2
    S = x.shape[1]
    xp = _pad(x, ((0, 0), (P, P), (0, 0)))
    y = sum(torch.einsum('bsc,cd->bsd', xp[:, k:k + S, :], w[k]) for k in range(K))
    inv_std = 1.0 / torch.sqrt(var + 1e-5)
    y = (y - mean) * (g * inv_std) + b
    return _silu(y)
```

```asm
; @launch grid=(234,1,1) block=(512,1,1) lds=162816
.amdgcn_target "amdgcn-amd-amdhsa--gfx950"
.text
.globl standalone__batchnorm__prompt_kernel
.p2align 8
.type standalone__batchnorm__prompt_kernel,@function
standalone__batchnorm__prompt_kernel:
    s_cmp_ge_u32 s2, 234
    s_cbranch_scc1 L_end
    s_load_dwordx16 s[4:19], s[0:1], 0
    v_lshrrev_b32 v2, 6, v0
    v_and_b32 v1, 63, v0
    s_and_b32 s48, s2, 7
    v_readfirstlane_b32 s57, v2
    s_lshr_b32 s49, s2, 3
    s_mul_i32 s50, s48, 29
    s_min_u32 s58, s48, 2
    s_add_u32 s50, s50, s58
    s_add_u32 s50, s50, s49
    s_mul_i32 s51, s50, 7282
    s_lshr_b32 s51, s51, 16
    s_mul_i32 s58, s51, 9
    s_sub_u32 s52, s50, s58
    s_cmp_ge_u32 s51, 13
    s_cselect_b32 s53, 1, 0
    s_mul_i32 s58, s53, 13
    s_sub_u32 s54, s51, s58
    s_mul_i32 s55, s54, 160
    s_lshl_b32 s56, s52, 6
    s_cmp_ge_u32 s57, 4
    s_cbranch_scc1 L_loader
    v_lshrrev_b32 v2, 4, v1
    v_and_b32 v3, 15, v1
    s_lshr_b32 s58, s57, 1
    s_mul_i32 s63, s58, 80
    s_and_b32 s64, s57, 1
    s_lshl_b32 s58, s64, 5
    s_add_u32 s58, s58, s56
    v_lshlrev_b32 v4, 2, v2
    v_add_u32 v4, s58, v4
    v_lshlrev_b32 v11, 1, v4
    v_add_u32 v4, s63, v3
    v_lshrrev_b32 v5, 1, v4
    v_and_b32 v5, 3, v5
    v_lshlrev_b32 v5, 1, v5
    v_lshlrev_b32 v6, 7, v4
    v_add_u32 v7, 0, v2
    v_xor_b32 v7, v7, v5
    v_lshl_add_u32 v12, v7, 4, v6
    v_add_u32 v7, 4, v2
    v_xor_b32 v7, v7, v5
    v_lshl_add_u32 v13, v7, 4, v6
    v_add_u32 v4, s63, v3
    v_add_u32 v4, 1, v4
    v_lshrrev_b32 v5, 1, v4
    v_and_b32 v5, 3, v5
    v_lshlrev_b32 v5, 1, v5
    v_lshlrev_b32 v6, 7, v4
    v_add_u32 v7, 0, v2
    v_xor_b32 v7, v7, v5
    v_lshl_add_u32 v14, v7, 4, v6
    v_add_u32 v7, 4, v2
    v_xor_b32 v7, v7, v5
    v_lshl_add_u32 v15, v7, 4, v6
    v_add_u32 v4, s63, v3
    v_add_u32 v4, 2, v4
    v_lshrrev_b32 v5, 1, v4
    v_and_b32 v5, 3, v5
    v_lshlrev_b32 v5, 1, v5
    v_lshlrev_b32 v6, 7, v4
    v_add_u32 v7, 0, v2
    v_xor_b32 v7, v7, v5
    v_lshl_add_u32 v16, v7, 4, v6
    v_add_u32 v7, 4, v2
    v_xor_b32 v7, v7, v5
    v_lshl_add_u32 v17, v7, 4, v6
    v_lshrrev_b32 v4, 2, v3
    v_and_b32 v5, 3, v3
    v_lshl_add_u32 v6, v2, 3, v4
    v_lshlrev_b32 v6, 7, v6
    v_and_b32 v7, 1, v2
    v_lshlrev_b32 v7, 2, v7
    v_lshrrev_b32 v8, 1, v4
    v_and_b32 v8, 1, v8
    v_lshl_add_u32 v7, v8, 1, v7
    v_and_b32 v8, 1, v5
    v_lshl_add_u32 v6, v8, 3, v6
    v_lshrrev_b32 v8, 1, v5
    s_lshl_b32 s58, s64, 2
    v_add_u32 v8, s58, v8
    v_add_u32 v9, 0, v8
    v_xor_b32 v9, v9, v7
    v_lshl_add_u32 v9, v9, 4, v6
    v_add_u32 v18, 64512, v9
    v_add_u32 v20, 130048, v9
    v_add_u32 v9, 2, v8
    v_xor_b32 v9, v9, v7
    v_lshl_add_u32 v9, v9, 4, v6
    v_add_u32 v19, 64512, v9
    v_add_u32 v21, 130048, v9
    s_add_u32 s58, s55, s63
    v_add_u32 v4, s58, v3
    s_movk_i32 s59, 1152
    v_mul_lo_u32 v10, v4, s59
    v_and_b32 v5, 1, v2
    v_lshlrev_b32 v5, 5, v5
    v_lshrrev_b32 v6, 1, v2
    v_lshl_add_u32 v5, v6, 4, v5
    s_lshl_b32 s58, s64, 5
    s_add_u32 s58, s58, s56
    s_lshl_b32 s58, s58, 1
    v_add_u32 v10, v10, v5
    v_add_u32 v10, s58, v10
    v_mov_b32 v54, 1.0
    v_mov_b32 v55, 1.0
    s_waitcnt lgkmcnt(0)
    s_mul_i32 s58, s53, 2359296
    s_add_u32 s28, s16, s58
    s_addc_u32 s29, s17, 0
    s_and_b32 s29, s29, 0xffff
    s_mov_b32 s30, 2359296
    s_mov_b32 s31, 0x00020000
    s_mov_b32 s32, s8
    s_and_b32 s33, s9, 0xffff
    s_mov_b32 s34, 1152
    s_mov_b32 s35, 0x00020000
    s_mov_b32 s36, s10
    s_and_b32 s37, s11, 0xffff
    s_mov_b32 s38, 1152
    s_mov_b32 s39, 0x00020000
    s_mov_b32 s40, s12
    s_and_b32 s41, s13, 0xffff
    s_mov_b32 s42, 1152
    s_mov_b32 s43, 0x00020000
    s_mov_b32 s44, s14
    s_and_b32 s45, s15, 0xffff
    s_mov_b32 s46, 1152
    s_mov_b32 s47, 0x00020000
    buffer_load_dwordx2 v[160:161], v11, s[32:35], 0 offen
    buffer_load_dwordx2 v[162:163], v11, s[32:35], 0 offen offset:32
    buffer_load_dwordx2 v[164:165], v11, s[36:39], 0 offen
    buffer_load_dwordx2 v[166:167], v11, s[36:39], 0 offen offset:32
    buffer_load_dwordx2 v[168:169], v11, s[40:43], 0 offen
    buffer_load_dwordx2 v[170:171], v11, s[40:43], 0 offen offset:32
    buffer_load_dwordx2 v[172:173], v11, s[44:47], 0 offen
    buffer_load_dwordx2 v[174:175], v11, s[44:47], 0 offen offset:32
    s_waitcnt vmcnt(0)
    s_mov_b32 s58, 0x3727c5ac
    s_mov_b32 s59, 0xbfb8aa3b
    v_lshlrev_b32 v4, 16, v164
    v_and_b32 v5, 0xffff0000, v164
    v_add_f32 v4, s58, v4
    v_add_f32 v5, s58, v5
    v_cvt_pk_bf16_f32 v6, v4, v5
    s_nop 0
    v_lshlrev_b32 v4, 16, v6
    v_and_b32 v5, 0xffff0000, v6
    v_sqrt_f32 v4, v4
    v_sqrt_f32 v5, v5
    s_nop 0
    v_cvt_pk_bf16_f32 v6, v4, v5
    s_nop 0
    v_lshlrev_b32 v4, 16, v6
    v_and_b32 v5, 0xffff0000, v6
    v_rcp_f32 v4, v4
    v_rcp_f32 v5, v5
    s_nop 0
    v_cvt_pk_bf16_f32 v6, v4, v5
    s_nop 0
    v_lshlrev_b32 v4, 16, v6
    v_and_b32 v5, 0xffff0000, v6
    v_lshlrev_b32 v7, 16, v168
    v_and_b32 v8, 0xffff0000, v168
    v_mul_f32 v4, v4, v7
    v_mul_f32 v5, v5, v8
    v_cvt_pk_bf16_f32 v6, v4, v5
    s_nop 0
    v_lshlrev_b32 v4, 16, v6
    v_and_b32 v5, 0xffff0000, v6
    v_mov_b32 v22, v4
    v_mov_b32 v23, v5
    v_lshlrev_b32 v7, 16, v160
    v_and_b32 v8, 0xffff0000, v160
    v_lshlrev_b32 v9, 16, v172
    v_and_b32 v6, 0xffff0000, v172
    v_fma_f32 v30, -v7, v4, v9
    v_fma_f32 v31, -v8, v5, v6
    v_mul_f32 v38, s59, v4
    v_mul_f32 v39, s59, v5
    v_mul_f32 v46, s59, v30
    v_mul_f32 v47, s59, v31
    v_lshlrev_b32 v4, 16, v165
    v_and_b32 v5, 0xffff0000, v165
    v_add_f32 v4, s58, v4
    v_add_f32 v5, s58, v5
    v_cvt_pk_bf16_f32 v6, v4, v5
    s_nop 0
    v_lshlrev_b32 v4, 16, v6
    v_and_b32 v5, 0xffff0000, v6
    v_sqrt_f32 v4, v4
    v_sqrt_f32 v5, v5
    s_nop 0
    v_cvt_pk_bf16_f32 v6, v4, v5
    s_nop 0
    v_lshlrev_b32 v4, 16, v6
    v_and_b32 v5, 0xffff0000, v6
    v_rcp_f32 v4, v4
    v_rcp_f32 v5, v5
    s_nop 0
    v_cvt_pk_bf16_f32 v6, v4, v5
    s_nop 0
    v_lshlrev_b32 v4, 16, v6
    v_and_b32 v5, 0xffff0000, v6
    v_lshlrev_b32 v7, 16, v169
    v_and_b32 v8, 0xffff0000, v169
    v_mul_f32 v4, v4, v7
    v_mul_f32 v5, v5, v8
    v_cvt_pk_bf16_f32 v6, v4, v5
    s_nop 0
    v_lshlrev_b32 v4, 16, v6
    v_and_b32 v5, 0xffff0000, v6
    v_mov_b32 v24, v4
    v_mov_b32 v25, v5
    v_lshlrev_b32 v7, 16, v161
    v_and_b32 v8, 0xffff0000, v161
    v_lshlrev_b32 v9, 16, v173
    v_and_b32 v6, 0xffff0000, v173
    v_fma_f32 v32, -v7, v4, v9
    v_fma_f32 v33, -v8, v5, v6
    v_mul_f32 v40, s59, v4
    v_mul_f32 v41, s59, v5
    v_mul_f32 v48, s59, v32
    v_mul_f32 v49, s59, v33
    v_lshlrev_b32 v4, 16, v166
    v_and_b32 v5, 0xffff0000, v166
    v_add_f32 v4, s58, v4
    v_add_f32 v5, s58, v5
    v_cvt_pk_bf16_f32 v6, v4, v5
    s_nop 0
    v_lshlrev_b32 v4, 16, v6
    v_and_b32 v5, 0xffff0000, v6
    v_sqrt_f32 v4, v4
    v_sqrt_f32 v5, v5
    s_nop 0
    v_cvt_pk_bf16_f32 v6, v4, v5
    s_nop 0
    v_lshlrev_b32 v4, 16, v6
    v_and_b32 v5, 0xffff0000, v6
    v_rcp_f32 v4, v4
    v_rcp_f32 v5, v5
    s_nop 0
    v_cvt_pk_bf16_f32 v6, v4, v5
    s_nop 0
    v_lshlrev_b32 v4, 16, v6
    v_and_b32 v5, 0xffff0000, v6
    v_lshlrev_b32 v7, 16, v170
    v_and_b32 v8, 0xffff0000, v170
    v_mul_f32 v4, v4, v7
    v_mul_f32 v5, v5, v8
    v_cvt_pk_bf16_f32 v6, v4, v5
    s_nop 0
    v_lshlrev_b32 v4, 16, v6
    v_and_b32 v5, 0xffff0000, v6
    v_mov_b32 v26, v4
    v_mov_b32 v27, v5
    v_lshlrev_b32 v7, 16, v162
    v_and_b32 v8, 0xffff0000, v162
    v_lshlrev_b32 v9, 16, v174
    v_and_b32 v6, 0xffff0000, v174
    v_fma_f32 v34, -v7, v4, v9
    v_fma_f32 v35, -v8, v5, v6
    v_mul_f32 v42, s59, v4
    v_mul_f32 v43, s59, v5
    v_mul_f32 v50, s59, v34
    v_mul_f32 v51, s59, v35
    v_lshlrev_b32 v4, 16, v167
    v_and_b32 v5, 0xffff0000, v167
    v_add_f32 v4, s58, v4
    v_add_f32 v5, s58, v5
    v_cvt_pk_bf16_f32 v6, v4, v5
    s_nop 0
    v_lshlrev_b32 v4, 16, v6
    v_and_b32 v5, 0xffff0000, v6
    v_sqrt_f32 v4, v4
    v_sqrt_f32 v5, v5
    s_nop 0
    v_cvt_pk_bf16_f32 v6, v4, v5
    s_nop 0
    v_lshlrev_b32 v4, 16, v6
    v_and_b32 v5, 0xffff0000, v6
    v_rcp_f32 v4, v4
    v_rcp_f32 v5, v5
    s_nop 0
    v_cvt_pk_bf16_f32 v6, v4, v5
    s_nop 0
    v_lshlrev_b32 v4, 16, v6
    v_and_b32 v5, 0xffff0000, v6
    v_lshlrev_b32 v7, 16, v171
    v_and_b32 v8, 0xffff0000, v171
    v_mul_f32 v4, v4, v7
    v_mul_f32 v5, v5, v8
    v_cvt_pk_bf16_f32 v6, v4, v5
    s_nop 0
    v_lshlrev_b32 v4, 16, v6
    v_and_b32 v5, 0xffff0000, v6
    v_mov_b32 v28, v4
    v_mov_b32 v29, v5
    v_lshlrev_b32 v7, 16, v163
    v_and_b32 v8, 0xffff0000, v163
    v_lshlrev_b32 v9, 16, v175
    v_and_b32 v6, 0xffff0000, v175
    v_fma_f32 v36, -v7, v4, v9
    v_fma_f32 v37, -v8, v5, v6
    v_mul_f32 v44, s59, v4
    v_mul_f32 v45, s59, v5
    v_mul_f32 v52, s59, v36
    v_mul_f32 v53, s59, v37
    s_barrier
    ds_read_b64_tr_b16 v[144:145], v18 offset:0
    ds_read_b64_tr_b16 v[146:147], v18 offset:512
    ds_read_b128 v[96:99], v12 offset:0
    ds_read_b64_tr_b16 v[148:149], v19 offset:0
    ds_read_b64_tr_b16 v[150:151], v19 offset:512
    ds_read_b128 v[100:103], v12 offset:2048
    ds_read_b128 v[104:107], v12 offset:4096
    ds_read_b128 v[108:111], v12 offset:6144
    ds_read_b128 v[112:115], v12 offset:8192
    s_waitcnt lgkmcnt(6)
    v_mfma_f32_16x16x32_bf16 v[56:59], v[144:147], v[96:99], 0
    ds_read_b64_tr_b16 v[152:153], v18 offset:4096
    s_waitcnt lgkmcnt(5)
    v_mfma_f32_16x16x32_bf16 v[60:63], v[148:151], v[96:99], 0
    ds_read_b64_tr_b16 v[154:155], v18 offset:4608
    s_waitcnt lgkmcnt(5)
    v_mfma_f32_16x16x32_bf16 v[64:67], v[144:147], v[100:103], 0
    ds_read_b128 v[120:123], v14 offset:0
    v_mfma_f32_16x16x32_bf16 v[68:71], v[148:151], v[100:103], 0
    ds_read_b64_tr_b16 v[156:157], v19 offset:4096
    s_waitcnt lgkmcnt(6)
    v_mfma_f32_16x16x32_bf16 v[72:75], v[144:147], v[104:107], 0
    ds_read_b64_tr_b16 v[158:159], v19 offset:4608
    v_mfma_f32_16x16x32_bf16 v[76:79], v[148:151], v[104:107], 0
    ds_read_b128 v[124:127], v14 offset:2048
    s_waitcnt lgkmcnt(7)
    v_mfma_f32_16x16x32_bf16 v[80:83], v[144:147], v[108:111], 0
    ds_read_b128 v[128:131], v14 offset:4096
    v_mfma_f32_16x16x32_bf16 v[84:87], v[148:151], v[108:111], 0
    ds_read_b128 v[132:135], v14 offset:6144
    s_waitcnt lgkmcnt(8)
    v_mfma_f32_16x16x32_bf16 v[88:91], v[144:147], v[112:115], 0
    ds_read_b128 v[136:139], v14 offset:8192
    v_mfma_f32_16x16x32_bf16 v[92:95], v[148:151], v[112:115], 0
    s_waitcnt lgkmcnt(6)
    v_mfma_f32_16x16x32_bf16 v[56:59], v[152:155], v[120:123], v[56:59]
    ds_read_b64_tr_b16 v[144:145], v18 offset:8192
    s_waitcnt lgkmcnt(5)
    v_mfma_f32_16x16x32_bf16 v[60:63], v[156:159], v[120:123], v[60:63]
    ds_read_b64_tr_b16 v[146:147], v18 offset:8704
    s_waitcnt lgkmcnt(5)
    v_mfma_f32_16x16x32_bf16 v[64:67], v[152:155], v[124:127], v[64:67]
    ds_read_b128 v[96:99], v16 offset:0
    v_mfma_f32_16x16x32_bf16 v[68:71], v[156:159], v[124:127], v[68:71]
    ds_read_b64_tr_b16 v[148:149], v19 offset:8192
    s_waitcnt lgkmcnt(6)
    v_mfma_f32_16x16x32_bf16 v[72:75], v[152:155], v[128:131], v[72:75]
    ds_read_b64_tr_b16 v[150:151], v19 offset:8704
    v_mfma_f32_16x16x32_bf16 v[76:79], v[156:159], v[128:131], v[76:79]
    ds_read_b128 v[100:103], v16 offset:2048
    s_waitcnt lgkmcnt(7)
    v_mfma_f32_16x16x32_bf16 v[80:83], v[152:155], v[132:135], v[80:83]
    ds_read_b128 v[104:107], v16 offset:4096
    v_mfma_f32_16x16x32_bf16 v[84:87], v[156:159], v[132:135], v[84:87]
    ds_read_b128 v[108:111], v16 offset:6144
    s_waitcnt lgkmcnt(8)
    v_mfma_f32_16x16x32_bf16 v[88:91], v[152:155], v[136:139], v[88:91]
    ds_read_b128 v[112:115], v16 offset:8192
    v_mfma_f32_16x16x32_bf16 v[92:95], v[156:159], v[136:139], v[92:95]
    s_waitcnt lgkmcnt(6)
    v_mfma_f32_16x16x32_bf16 v[56:59], v[144:147], v[96:99], v[56:59]
    ds_read_b64_tr_b16 v[152:153], v18 offset:12288
    s_waitcnt lgkmcnt(5)
    v_mfma_f32_16x16x32_bf16 v[60:63], v[148:151], v[96:99], v[60:63]
    ds_read_b64_tr_b16 v[154:155], v18 offset:12800
    s_waitcnt lgkmcnt(5)
    v_mfma_f32_16x16x32_bf16 v[64:67], v[144:147], v[100:103], v[64:67]
    ds_read_b128 v[120:123], v13 offset:0
    v_mfma_f32_16x16x32_bf16 v[68:71], v[148:151], v[100:103], v[68:71]
    ds_read_b64_tr_b16 v[156:157], v19 offset:12288
    s_waitcnt lgkmcnt(6)
    v_mfma_f32_16x16x32_bf16 v[72:75], v[144:147], v[104:107], v[72:75]
    ds_read_b64_tr_b16 v[158:159], v19 offset:12800
    v_mfma_f32_16x16x32_bf16 v[76:79], v[148:151], v[104:107], v[76:79]
    ds_read_b128 v[124:127], v13 offset:2048
    s_waitcnt lgkmcnt(7)
    v_mfma_f32_16x16x32_bf16 v[80:83], v[144:147], v[108:111], v[80:83]
    ds_read_b128 v[128:131], v13 offset:4096
    v_mfma_f32_16x16x32_bf16 v[84:87], v[148:151], v[108:111], v[84:87]
    ds_read_b128 v[132:135], v13 offset:6144
    s_waitcnt lgkmcnt(8)
    v_mfma_f32_16x16x32_bf16 v[88:91], v[144:147], v[112:115], v[88:91]
    ds_read_b128 v[136:139], v13 offset:8192
    v_mfma_f32_16x16x32_bf16 v[92:95], v[148:151], v[112:115], v[92:95]
    s_waitcnt lgkmcnt(6)
    v_mfma_f32_16x16x32_bf16 v[56:59], v[152:155], v[120:123], v[56:59]
    ds_read_b64_tr_b16 v[144:145], v18 offset:16384
    s_waitcnt lgkmcnt(5)
    v_mfma_f32_16x16x32_bf16 v[60:63], v[156:159], v[120:123], v[60:63]
    ds_read_b64_tr_b16 v[146:147], v18 offset:16896
    s_waitcnt lgkmcnt(5)
    v_mfma_f32_16x16x32_bf16 v[64:67], v[152:155], v[124:127], v[64:67]
    ds_read_b128 v[96:99], v15 offset:0
    v_mfma_f32_16x16x32_bf16 v[68:71], v[156:159], v[124:127], v[68:71]
    ds_read_b64_tr_b16 v[148:149], v19 offset:16384
    s_waitcnt lgkmcnt(6)
    v_mfma_f32_16x16x32_bf16 v[72:75], v[152:155], v[128:131], v[72:75]
    ds_read_b64_tr_b16 v[150:151], v19 offset:16896
    v_mfma_f32_16x16x32_bf16 v[76:79], v[156:159], v[128:131], v[76:79]
    ds_read_b128 v[100:103], v15 offset:2048
    s_waitcnt lgkmcnt(7)
    v_mfma_f32_16x16x32_bf16 v[80:83], v[152:155], v[132:135], v[80:83]
    ds_read_b128 v[104:107], v15 offset:4096
    v_mfma_f32_16x16x32_bf16 v[84:87], v[156:159], v[132:135], v[84:87]
    ds_read_b128 v[108:111], v15 offset:6144
    s_waitcnt lgkmcnt(8)
    v_mfma_f32_16x16x32_bf16 v[88:91], v[152:155], v[136:139], v[88:91]
    ds_read_b128 v[112:115], v15 offset:8192
    v_mfma_f32_16x16x32_bf16 v[92:95], v[156:159], v[136:139], v[92:95]
    s_waitcnt lgkmcnt(6)
    v_mfma_f32_16x16x32_bf16 v[56:59], v[144:147], v[96:99], v[56:59]
    ds_read_b64_tr_b16 v[152:153], v18 offset:20480
    s_waitcnt lgkmcnt(5)
    v_mfma_f32_16x16x32_bf16 v[60:63], v[148:151], v[96:99], v[60:63]
    ds_read_b64_tr_b16 v[154:155], v18 offset:20992
    s_waitcnt lgkmcnt(5)
    v_mfma_f32_16x16x32_bf16 v[64:67], v[144:147], v[100:103], v[64:67]
    ds_read_b128 v[120:123], v17 offset:0
    v_mfma_f32_16x16x32_bf16 v[68:71], v[148:151], v[100:103], v[68:71]
    ds_read_b64_tr_b16 v[156:157], v19 offset:20480
    s_waitcnt lgkmcnt(6)
    v_mfma_f32_16x16x32_bf16 v[72:75], v[144:147], v[104:107], v[72:75]
    ds_read_b64_tr_b16 v[158:159], v19 offset:20992
    v_mfma_f32_16x16x32_bf16 v[76:79], v[148:151], v[104:107], v[76:79]
    ds_read_b128 v[124:127], v17 offset:2048
    s_waitcnt lgkmcnt(7)
    v_mfma_f32_16x16x32_bf16 v[80:83], v[144:147], v[108:111], v[80:83]
    ds_read_b128 v[128:131], v17 offset:4096
    v_mfma_f32_16x16x32_bf16 v[84:87], v[148:151], v[108:111], v[84:87]
    ds_read_b128 v[132:135], v17 offset:6144
    s_waitcnt lgkmcnt(8)
    v_mfma_f32_16x16x32_bf16 v[88:91], v[144:147], v[112:115], v[88:91]
    ds_read_b128 v[136:139], v17 offset:8192
    v_mfma_f32_16x16x32_bf16 v[92:95], v[148:151], v[112:115], v[92:95]
    s_waitcnt lgkmcnt(0)
    s_barrier
    v_mfma_f32_16x16x32_bf16 v[56:59], v[152:155], v[120:123], v[56:59]
    ds_read_b64_tr_b16 v[144:145], v18 offset:24576
    v_mfma_f32_16x16x32_bf16 v[60:63], v[156:159], v[120:123], v[60:63]
    ds_read_b64_tr_b16 v[146:147], v18 offset:25088
    v_mfma_f32_16x16x32_bf16 v[64:67], v[152:155], v[124:127], v[64:67]
    ds_read_b128 v[96:99], v12 offset:21504
    v_mfma_f32_16x16x32_bf16 v[68:71], v[156:159], v[124:127], v[68:71]
    ds_read_b64_tr_b16 v[148:149], v19 offset:24576
    v_mfma_f32_16x16x32_bf16 v[72:75], v[152:155], v[128:131], v[72:75]
    ds_read_b64_tr_b16 v[150:151], v19 offset:25088
    v_mfma_f32_16x16x32_bf16 v[76:79], v[156:159], v[128:131], v[76:79]
    ds_read_b128 v[100:103], v12 offset:23552
    v_mfma_f32_16x16x32_bf16 v[80:83], v[152:155], v[132:135], v[80:83]
    ds_read_b128 v[104:107], v12 offset:25600
    v_mfma_f32_16x16x32_bf16 v[84:87], v[156:159], v[132:135], v[84:87]
    ds_read_b128 v[108:111], v12 offset:27648
    v_mfma_f32_16x16x32_bf16 v[88:91], v[152:155], v[136:139], v[88:91]
    ds_read_b128 v[112:115], v12 offset:29696
    v_mfma_f32_16x16x32_bf16 v[92:95], v[156:159], v[136:139], v[92:95]
    s_waitcnt lgkmcnt(6)
    v_mfma_f32_16x16x32_bf16 v[56:59], v[144:147], v[96:99], v[56:59]
    ds_read_b64_tr_b16 v[152:153], v18 offset:28672
    s_waitcnt lgkmcnt(5)
    v_mfma_f32_16x16x32_bf16 v[60:63], v[148:151], v[96:99], v[60:63]
    ds_read_b64_tr_b16 v[154:155], v18 offset:29184
    s_waitcnt lgkmcnt(5)
    v_mfma_f32_16x16x32_bf16 v[64:67], v[144:147], v[100:103], v[64:67]
    ds_read_b128 v[120:123], v14 offset:21504
    v_mfma_f32_16x16x32_bf16 v[68:71], v[148:151], v[100:103], v[68:71]
    ds_read_b64_tr_b16 v[156:157], v19 offset:28672
    s_waitcnt lgkmcnt(6)
    v_mfma_f32_16x16x32_bf16 v[72:75], v[144:147], v[104:107], v[72:75]
    ds_read_b64_tr_b16 v[158:159], v19 offset:29184
    v_mfma_f32_16x16x32_bf16 v[76:79], v[148:151], v[104:107], v[76:79]
    ds_read_b128 v[124:127], v14 offset:23552
    s_waitcnt lgkmcnt(7)
    v_mfma_f32_16x16x32_bf16 v[80:83], v[144:147], v[108:111], v[80:83]
    ds_read_b128 v[128:131], v14 offset:25600
    v_mfma_f32_16x16x32_bf16 v[84:87], v[148:151], v[108:111], v[84:87]
    ds_read_b128 v[132:135], v14 offset:27648
    s_waitcnt lgkmcnt(8)
    v_mfma_f32_16x16x32_bf16 v[88:91], v[144:147], v[112:115], v[88:91]
    ds_read_b128 v[136:139], v14 offset:29696
    v_mfma_f32_16x16x32_bf16 v[92:95], v[148:151], v[112:115], v[92:95]
    s_waitcnt lgkmcnt(6)
    v_mfma_f32_16x16x32_bf16 v[56:59], v[152:155], v[120:123], v[56:59]
    ds_read_b64_tr_b16 v[144:145], v18 offset:32768
    s_waitcnt lgkmcnt(5)
    v_mfma_f32_16x16x32_bf16 v[60:63], v[156:159], v[120:123], v[60:63]
    ds_read_b64_tr_b16 v[146:147], v18 offset:33280
    s_waitcnt lgkmcnt(5)
    v_mfma_f32_16x16x32_bf16 v[64:67], v[152:155], v[124:127], v[64:67]
    ds_read_b128 v[96:99], v16 offset:21504
    v_mfma_f32_16x16x32_bf16 v[68:71], v[156:159], v[124:127], v[68:71]
    ds_read_b64_tr_b16 v[148:149], v19 offset:32768
    s_waitcnt lgkmcnt(6)
    v_mfma_f32_16x16x32_bf16 v[72:75], v[152:155], v[128:131], v[72:75]
    ds_read_b64_tr_b16 v[150:151], v19 offset:33280
    v_mfma_f32_16x16x32_bf16 v[76:79], v[156:159], v[128:131], v[76:79]
    ds_read_b128 v[100:103], v16 offset:23552
    s_waitcnt lgkmcnt(7)
    v_mfma_f32_16x16x32_bf16 v[80:83], v[152:155], v[132:135], v[80:83]
    ds_read_b128 v[104:107], v16 offset:25600
    v_mfma_f32_16x16x32_bf16 v[84:87], v[156:159], v[132:135], v[84:87]
    ds_read_b128 v[108:111], v16 offset:27648
    s_waitcnt lgkmcnt(8)
    v_mfma_f32_16x16x32_bf16 v[88:91], v[152:155], v[136:139], v[88:91]
    ds_read_b128 v[112:115], v16 offset:29696
    v_mfma_f32_16x16x32_bf16 v[92:95], v[156:159], v[136:139], v[92:95]
    s_waitcnt lgkmcnt(6)
    v_mfma_f32_16x16x32_bf16 v[56:59], v[144:147], v[96:99], v[56:59]
    ds_read_b64_tr_b16 v[152:153], v18 offset:36864
    s_waitcnt lgkmcnt(5)
    v_mfma_f32_16x16x32_bf16 v[60:63], v[148:151], v[96:99], v[60:63]
    ds_read_b64_tr_b16 v[154:155], v18 offset:37376
    s_waitcnt lgkmcnt(5)
    v_mfma_f32_16x16x32_bf16 v[64:67], v[144:147], v[100:103], v[64:67]
    ds_read_b128 v[120:123], v13 offset:21504
    v_mfma_f32_16x16x32_bf16 v[68:71], v[148:151], v[100:103], v[68:71]
    ds_read_b64_tr_b16 v[156:157], v19 offset:36864
    s_waitcnt lgkmcnt(6)
    v_mfma_f32_16x16x32_bf16 v[72:75], v[144:147], v[104:107], v[72:75]
    ds_read_b64_tr_b16 v[158:159], v19 offset:37376
    v_mfma_f32_16x16x32_bf16 v[76:79], v[148:151], v[104:107], v[76:79]
    ds_read_b128 v[124:127], v13 offset:23552
    s_waitcnt lgkmcnt(7)
    v_mfma_f32_16x16x32_bf16 v[80:83], v[144:147], v[108:111], v[80:83]
    ds_read_b128 v[128:131], v13 offset:25600
    v_mfma_f32_16x16x32_bf16 v[84:87], v[148:151], v[108:111], v[84:87]
    ds_read_b128 v[132:135], v13 offset:27648
    s_waitcnt lgkmcnt(8)
    v_mfma_f32_16x16x32_bf16 v[88:91], v[144:147], v[112:115], v[88:91]
    ds_read_b128 v[136:139], v13 offset:29696
    v_mfma_f32_16x16x32_bf16 v[92:95], v[148:151], v[112:115], v[92:95]
    s_waitcnt lgkmcnt(6)
    v_mfma_f32_16x16x32_bf16 v[56:59], v[152:155], v[120:123], v[56:59]
    ds_read_b64_tr_b16 v[144:145], v18 offset:40960
    s_waitcnt lgkmcnt(5)
    v_mfma_f32_16x16x32_bf16 v[60:63], v[156:159], v[120:123], v[60:63]
    ds_read_b64_tr_b16 v[146:147], v18 offset:41472
    s_waitcnt lgkmcnt(5)
    v_mfma_f32_16x16x32_bf16 v[64:67], v[152:155], v[124:127], v[64:67]
    ds_read_b128 v[96:99], v15 offset:21504
    v_mfma_f32_16x16x32_bf16 v[68:71], v[156:159], v[124:127], v[68:71]
    ds_read_b64_tr_b16 v[148:149], v19 offset:40960
    s_waitcnt lgkmcnt(6)
    v_mfma_f32_16x16x32_bf16 v[72:75], v[152:155], v[128:131], v[72:75]
    ds_read_b64_tr_b16 v[150:151], v19 offset:41472
    v_mfma_f32_16x16x32_bf16 v[76:79], v[156:159], v[128:131], v[76:79]
    ds_read_b128 v[100:103], v15 offset:23552
    s_waitcnt lgkmcnt(7)
    v_mfma_f32_16x16x32_bf16 v[80:83], v[152:155], v[132:135], v[80:83]
    ds_read_b128 v[104:107], v15 offset:25600
    v_mfma_f32_16x16x32_bf16 v[84:87], v[156:159], v[132:135], v[84:87]
    ds_read_b128 v[108:111], v15 offset:27648
    s_waitcnt lgkmcnt(8)
    v_mfma_f32_16x16x32_bf16 v[88:91], v[152:155], v[136:139], v[88:91]
    ds_read_b128 v[112:115], v15 offset:29696
    v_mfma_f32_16x16x32_bf16 v[92:95], v[156:159], v[136:139], v[92:95]
    s_waitcnt lgkmcnt(6)
    v_mfma_f32_16x16x32_bf16 v[56:59], v[144:147], v[96:99], v[56:59]
    ds_read_b64_tr_b16 v[152:153], v18 offset:45056
    s_waitcnt lgkmcnt(5)
    v_mfma_f32_16x16x32_bf16 v[60:63], v[148:151], v[96:99], v[60:63]
    ds_read_b64_tr_b16 v[154:155], v18 offset:45568
    s_waitcnt lgkmcnt(5)
    v_mfma_f32_16x16x32_bf16 v[64:67], v[144:147], v[100:103], v[64:67]
    ds_read_b128 v[120:123], v17 offset:21504
    v_mfma_f32_16x16x32_bf16 v[68:71], v[148:151], v[100:103], v[68:71]
    ds_read_b64_tr_b16 v[156:157], v19 offset:45056
    s_waitcnt lgkmcnt(6)
    v_mfma_f32_16x16x32_bf16 v[72:75], v[144:147], v[104:107], v[72:75]
    ds_read_b64_tr_b16 v[158:159], v19 offset:45568
    v_mfma_f32_16x16x32_bf16 v[76:79], v[148:151], v[104:107], v[76:79]
    ds_read_b128 v[124:127], v17 offset:23552
    s_waitcnt lgkmcnt(7)
    v_mfma_f32_16x16x32_bf16 v[80:83], v[144:147], v[108:111], v[80:83]
    ds_read_b128 v[128:131], v17 offset:25600
    v_mfma_f32_16x16x32_bf16 v[84:87], v[148:151], v[108:111], v[84:87]
    ds_read_b128 v[132:135], v17 offset:27648
    s_waitcnt lgkmcnt(8)
    v_mfma_f32_16x16x32_bf16 v[88:91], v[144:147], v[112:115], v[88:91]
    ds_read_b128 v[136:139], v17 offset:29696
    v_mfma_f32_16x16x32_bf16 v[92:95], v[148:151], v[112:115], v[92:95]
    s_waitcnt lgkmcnt(0)
    s_barrier
    v_mfma_f32_16x16x32_bf16 v[56:59], v[152:155], v[120:123], v[56:59]
    ds_read_b64_tr_b16 v[144:145], v18 offset:49152
    v_mfma_f32_16x16x32_bf16 v[60:63], v[156:159], v[120:123], v[60:63]
    ds_read_b64_tr_b16 v[146:147], v18 offset:49664
    v_mfma_f32_16x16x32_bf16 v[64:67], v[152:155], v[124:127], v[64:67]
    ds_read_b128 v[96:99], v12 offset:43008
    v_mfma_f32_16x16x32_bf16 v[68:71], v[156:159], v[124:127], v[68:71]
    ds_read_b64_tr_b16 v[148:149], v19 offset:49152
    v_mfma_f32_16x16x32_bf16 v[72:75], v[152:155], v[128:131], v[72:75]
    ds_read_b64_tr_b16 v[150:151], v19 offset:49664
    v_mfma_f32_16x16x32_bf16 v[76:79], v[156:159], v[128:131], v[76:79]
    ds_read_b128 v[100:103], v12 offset:45056
    v_mfma_f32_16x16x32_bf16 v[80:83], v[152:155], v[132:135], v[80:83]
    ds_read_b128 v[104:107], v12 offset:47104
    v_mfma_f32_16x16x32_bf16 v[84:87], v[156:159], v[132:135], v[84:87]
    ds_read_b128 v[108:111], v12 offset:49152
    v_mfma_f32_16x16x32_bf16 v[88:91], v[152:155], v[136:139], v[88:91]
    ds_read_b128 v[112:115], v12 offset:51200
    v_mfma_f32_16x16x32_bf16 v[92:95], v[156:159], v[136:139], v[92:95]
    s_waitcnt lgkmcnt(6)
    v_mfma_f32_16x16x32_bf16 v[56:59], v[144:147], v[96:99], v[56:59]
    ds_read_b64_tr_b16 v[152:153], v18 offset:53248
    s_waitcnt lgkmcnt(5)
    v_mfma_f32_16x16x32_bf16 v[60:63], v[148:151], v[96:99], v[60:63]
    ds_read_b64_tr_b16 v[154:155], v18 offset:53760
    s_waitcnt lgkmcnt(5)
    v_mfma_f32_16x16x32_bf16 v[64:67], v[144:147], v[100:103], v[64:67]
    ds_read_b128 v[120:123], v14 offset:43008
    v_mfma_f32_16x16x32_bf16 v[68:71], v[148:151], v[100:103], v[68:71]
    ds_read_b64_tr_b16 v[156:157], v19 offset:53248
    s_waitcnt lgkmcnt(6)
    v_mfma_f32_16x16x32_bf16 v[72:75], v[144:147], v[104:107], v[72:75]
    ds_read_b64_tr_b16 v[158:159], v19 offset:53760
    v_mfma_f32_16x16x32_bf16 v[76:79], v[148:151], v[104:107], v[76:79]
    ds_read_b128 v[124:127], v14 offset:45056
    s_waitcnt lgkmcnt(7)
    v_mfma_f32_16x16x32_bf16 v[80:83], v[144:147], v[108:111], v[80:83]
    ds_read_b128 v[128:131], v14 offset:47104
    v_mfma_f32_16x16x32_bf16 v[84:87], v[148:151], v[108:111], v[84:87]
    ds_read_b128 v[132:135], v14 offset:49152
    s_waitcnt lgkmcnt(8)
    v_mfma_f32_16x16x32_bf16 v[88:91], v[144:147], v[112:115], v[88:91]
    ds_read_b128 v[136:139], v14 offset:51200
    v_mfma_f32_16x16x32_bf16 v[92:95], v[148:151], v[112:115], v[92:95]
    s_waitcnt lgkmcnt(6)
    v_mfma_f32_16x16x32_bf16 v[56:59], v[152:155], v[120:123], v[56:59]
    ds_read_b64_tr_b16 v[144:145], v18 offset:57344
    s_waitcnt lgkmcnt(5)
    v_mfma_f32_16x16x32_bf16 v[60:63], v[156:159], v[120:123], v[60:63]
    ds_read_b64_tr_b16 v[146:147], v18 offset:57856
    s_waitcnt lgkmcnt(5)
    v_mfma_f32_16x16x32_bf16 v[64:67], v[152:155], v[124:127], v[64:67]
    ds_read_b128 v[96:99], v16 offset:43008
    v_mfma_f32_16x16x32_bf16 v[68:71], v[156:159], v[124:127], v[68:71]
    ds_read_b64_tr_b16 v[148:149], v19 offset:57344
    s_waitcnt lgkmcnt(6)
    v_mfma_f32_16x16x32_bf16 v[72:75], v[152:155], v[128:131], v[72:75]
    ds_read_b64_tr_b16 v[150:151], v19 offset:57856
    v_mfma_f32_16x16x32_bf16 v[76:79], v[156:159], v[128:131], v[76:79]
    ds_read_b128 v[100:103], v16 offset:45056
    s_waitcnt lgkmcnt(7)
    v_mfma_f32_16x16x32_bf16 v[80:83], v[152:155], v[132:135], v[80:83]
    ds_read_b128 v[104:107], v16 offset:47104
    v_mfma_f32_16x16x32_bf16 v[84:87], v[156:159], v[132:135], v[84:87]
    ds_read_b128 v[108:111], v16 offset:49152
    s_waitcnt lgkmcnt(8)
    v_mfma_f32_16x16x32_bf16 v[88:91], v[152:155], v[136:139], v[88:91]
    ds_read_b128 v[112:115], v16 offset:51200
    v_mfma_f32_16x16x32_bf16 v[92:95], v[156:159], v[136:139], v[92:95]
    s_waitcnt lgkmcnt(6)
    v_mfma_f32_16x16x32_bf16 v[56:59], v[144:147], v[96:99], v[56:59]
    ds_read_b64_tr_b16 v[152:153], v18 offset:61440
    s_waitcnt lgkmcnt(5)
    v_mfma_f32_16x16x32_bf16 v[60:63], v[148:151], v[96:99], v[60:63]
    ds_read_b64_tr_b16 v[154:155], v18 offset:61952
    s_waitcnt lgkmcnt(5)
    v_mfma_f32_16x16x32_bf16 v[64:67], v[144:147], v[100:103], v[64:67]
    ds_read_b128 v[120:123], v13 offset:43008
    v_mfma_f32_16x16x32_bf16 v[68:71], v[148:151], v[100:103], v[68:71]
    ds_read_b64_tr_b16 v[156:157], v19 offset:61440
    s_waitcnt lgkmcnt(6)
    v_mfma_f32_16x16x32_bf16 v[72:75], v[144:147], v[104:107], v[72:75]
    ds_read_b64_tr_b16 v[158:159], v19 offset:61952
    v_mfma_f32_16x16x32_bf16 v[76:79], v[148:151], v[104:107], v[76:79]
    ds_read_b128 v[124:127], v13 offset:45056
    s_waitcnt lgkmcnt(7)
    v_mfma_f32_16x16x32_bf16 v[80:83], v[144:147], v[108:111], v[80:83]
    ds_read_b128 v[128:131], v13 offset:47104
    v_mfma_f32_16x16x32_bf16 v[84:87], v[148:151], v[108:111], v[84:87]
    ds_read_b128 v[132:135], v13 offset:49152
    s_waitcnt lgkmcnt(8)
    v_mfma_f32_16x16x32_bf16 v[88:91], v[144:147], v[112:115], v[88:91]
    ds_read_b128 v[136:139], v13 offset:51200
    v_mfma_f32_16x16x32_bf16 v[92:95], v[148:151], v[112:115], v[92:95]
    s_waitcnt lgkmcnt(6)
    v_mfma_f32_16x16x32_bf16 v[56:59], v[152:155], v[120:123], v[56:59]
    ds_read_b64_tr_b16 v[144:145], v20 offset:0
    s_waitcnt lgkmcnt(5)
    v_mfma_f32_16x16x32_bf16 v[60:63], v[156:159], v[120:123], v[60:63]
    ds_read_b64_tr_b16 v[146:147], v20 offset:512
    s_waitcnt lgkmcnt(5)
    v_mfma_f32_16x16x32_bf16 v[64:67], v[152:155], v[124:127], v[64:67]
    ds_read_b128 v[96:99], v15 offset:43008
    v_mfma_f32_16x16x32_bf16 v[68:71], v[156:159], v[124:127], v[68:71]
    ds_read_b64_tr_b16 v[148:149], v21 offset:0
    s_waitcnt lgkmcnt(6)
    v_mfma_f32_16x16x32_bf16 v[72:75], v[152:155], v[128:131], v[72:75]
    ds_read_b64_tr_b16 v[150:151], v21 offset:512
    v_mfma_f32_16x16x32_bf16 v[76:79], v[156:159], v[128:131], v[76:79]
    ds_read_b128 v[100:103], v15 offset:45056
    s_waitcnt lgkmcnt(7)
    v_mfma_f32_16x16x32_bf16 v[80:83], v[152:155], v[132:135], v[80:83]
    ds_read_b128 v[104:107], v15 offset:47104
    v_mfma_f32_16x16x32_bf16 v[84:87], v[156:159], v[132:135], v[84:87]
    ds_read_b128 v[108:111], v15 offset:49152
    s_waitcnt lgkmcnt(8)
    v_mfma_f32_16x16x32_bf16 v[88:91], v[152:155], v[136:139], v[88:91]
    ds_read_b128 v[112:115], v15 offset:51200
    v_mfma_f32_16x16x32_bf16 v[92:95], v[156:159], v[136:139], v[92:95]
    s_waitcnt lgkmcnt(6)
    v_mfma_f32_16x16x32_bf16 v[56:59], v[144:147], v[96:99], v[56:59]
    ds_read_b64_tr_b16 v[152:153], v20 offset:4096
    s_waitcnt lgkmcnt(5)
    v_mfma_f32_16x16x32_bf16 v[60:63], v[148:151], v[96:99], v[60:63]
    ds_read_b64_tr_b16 v[154:155], v20 offset:4608
    s_waitcnt lgkmcnt(5)
    v_mfma_f32_16x16x32_bf16 v[64:67], v[144:147], v[100:103], v[64:67]
    ds_read_b128 v[120:123], v17 offset:43008
    v_mfma_f32_16x16x32_bf16 v[68:71], v[148:151], v[100:103], v[68:71]
    ds_read_b64_tr_b16 v[156:157], v21 offset:4096
    s_waitcnt lgkmcnt(6)
    v_mfma_f32_16x16x32_bf16 v[72:75], v[144:147], v[104:107], v[72:75]
    ds_read_b64_tr_b16 v[158:159], v21 offset:4608
    v_mfma_f32_16x16x32_bf16 v[76:79], v[148:151], v[104:107], v[76:79]
    ds_read_b128 v[124:127], v17 offset:45056
    s_waitcnt lgkmcnt(7)
    v_mfma_f32_16x16x32_bf16 v[80:83], v[144:147], v[108:111], v[80:83]
    ds_read_b128 v[128:131], v17 offset:47104
    v_mfma_f32_16x16x32_bf16 v[84:87], v[148:151], v[108:111], v[84:87]
    ds_read_b128 v[132:135], v17 offset:49152
    s_waitcnt lgkmcnt(8)
    v_mfma_f32_16x16x32_bf16 v[88:91], v[144:147], v[112:115], v[88:91]
    ds_read_b128 v[136:139], v17 offset:51200
    v_mfma_f32_16x16x32_bf16 v[92:95], v[148:151], v[112:115], v[92:95]
    s_waitcnt lgkmcnt(0)
    s_barrier
    v_mfma_f32_16x16x32_bf16 v[56:59], v[152:155], v[120:123], v[56:59]
    ds_read_b64_tr_b16 v[144:145], v20 offset:8192
    v_mfma_f32_16x16x32_bf16 v[60:63], v[156:159], v[120:123], v[60:63]
    ds_read_b64_tr_b16 v[146:147], v20 offset:8704
    v_mfma_f32_16x16x32_bf16 v[64:67], v[152:155], v[124:127], v[64:67]
    ds_read_b128 v[96:99], v12 offset:0
    v_mfma_f32_16x16x32_bf16 v[68:71], v[156:159], v[124:127], v[68:71]
    ds_read_b64_tr_b16 v[148:149], v21 offset:8192
    v_mfma_f32_16x16x32_bf16 v[72:75], v[152:155], v[128:131], v[72:75]
    ds_read_b64_tr_b16 v[150:151], v21 offset:8704
    v_mfma_f32_16x16x32_bf16 v[76:79], v[156:159], v[128:131], v[76:79]
    ds_read_b128 v[100:103], v12 offset:2048
    v_mfma_f32_16x16x32_bf16 v[80:83], v[152:155], v[132:135], v[80:83]
    ds_read_b128 v[104:107], v12 offset:4096
    v_mfma_f32_16x16x32_bf16 v[84:87], v[156:159], v[132:135], v[84:87]
    ds_read_b128 v[108:111], v12 offset:6144
    v_mfma_f32_16x16x32_bf16 v[88:91], v[152:155], v[136:139], v[88:91]
    ds_read_b128 v[112:115], v12 offset:8192
    v_mfma_f32_16x16x32_bf16 v[92:95], v[156:159], v[136:139], v[92:95]
    s_waitcnt lgkmcnt(6)
    v_mfma_f32_16x16x32_bf16 v[56:59], v[144:147], v[96:99], v[56:59]
    ds_read_b64_tr_b16 v[152:153], v20 offset:12288
    s_waitcnt lgkmcnt(5)
    v_mfma_f32_16x16x32_bf16 v[60:63], v[148:151], v[96:99], v[60:63]
    ds_read_b64_tr_b16 v[154:155], v20 offset:12800
    s_waitcnt lgkmcnt(5)
    v_mfma_f32_16x16x32_bf16 v[64:67], v[144:147], v[100:103], v[64:67]
    ds_read_b128 v[120:123], v14 offset:0
    v_mfma_f32_16x16x32_bf16 v[68:71], v[148:151], v[100:103], v[68:71]
    ds_read_b64_tr_b16 v[156:157], v21 offset:12288
    s_waitcnt lgkmcnt(6)
    v_mfma_f32_16x16x32_bf16 v[72:75], v[144:147], v[104:107], v[72:75]
    ds_read_b64_tr_b16 v[158:159], v21 offset:12800
    v_mfma_f32_16x16x32_bf16 v[76:79], v[148:151], v[104:107], v[76:79]
    ds_read_b128 v[124:127], v14 offset:2048
    s_waitcnt lgkmcnt(7)
    v_mfma_f32_16x16x32_bf16 v[80:83], v[144:147], v[108:111], v[80:83]
    ds_read_b128 v[128:131], v14 offset:4096
    v_mfma_f32_16x16x32_bf16 v[84:87], v[148:151], v[108:111], v[84:87]
    ds_read_b128 v[132:135], v14 offset:6144
    s_waitcnt lgkmcnt(8)
    v_mfma_f32_16x16x32_bf16 v[88:91], v[144:147], v[112:115], v[88:91]
    ds_read_b128 v[136:139], v14 offset:8192
    v_mfma_f32_16x16x32_bf16 v[92:95], v[148:151], v[112:115], v[92:95]
    s_waitcnt lgkmcnt(6)
    v_mfma_f32_16x16x32_bf16 v[56:59], v[152:155], v[120:123], v[56:59]
    ds_read_b64_tr_b16 v[144:145], v20 offset:16384
    s_waitcnt lgkmcnt(5)
    v_mfma_f32_16x16x32_bf16 v[60:63], v[156:159], v[120:123], v[60:63]
    ds_read_b64_tr_b16 v[146:147], v20 offset:16896
    s_waitcnt lgkmcnt(5)
    v_mfma_f32_16x16x32_bf16 v[64:67], v[152:155], v[124:127], v[64:67]
    ds_read_b128 v[96:99], v16 offset:0
    v_mfma_f32_16x16x32_bf16 v[68:71], v[156:159], v[124:127], v[68:71]
    ds_read_b64_tr_b16 v[148:149], v21 offset:16384
    s_waitcnt lgkmcnt(6)
    v_mfma_f32_16x16x32_bf16 v[72:75], v[152:155], v[128:131], v[72:75]
    ds_read_b64_tr_b16 v[150:151], v21 offset:16896
    v_mfma_f32_16x16x32_bf16 v[76:79], v[156:159], v[128:131], v[76:79]
    ds_read_b128 v[100:103], v16 offset:2048
    s_waitcnt lgkmcnt(7)
    v_mfma_f32_16x16x32_bf16 v[80:83], v[152:155], v[132:135], v[80:83]
    ds_read_b128 v[104:107], v16 offset:4096
    v_mfma_f32_16x16x32_bf16 v[84:87], v[156:159], v[132:135], v[84:87]
    ds_read_b128 v[108:111], v16 offset:6144
    s_waitcnt lgkmcnt(8)
    v_mfma_f32_16x16x32_bf16 v[88:91], v[152:155], v[136:139], v[88:91]
    ds_read_b128 v[112:115], v16 offset:8192
    v_mfma_f32_16x16x32_bf16 v[92:95], v[156:159], v[136:139], v[92:95]
    s_waitcnt lgkmcnt(6)
    v_mfma_f32_16x16x32_bf16 v[56:59], v[144:147], v[96:99], v[56:59]
    ds_read_b64_tr_b16 v[152:153], v20 offset:20480
    s_waitcnt lgkmcnt(5)
    v_mfma_f32_16x16x32_bf16 v[60:63], v[148:151], v[96:99], v[60:63]
    ds_read_b64_tr_b16 v[154:155], v20 offset:20992
    s_waitcnt lgkmcnt(5)
    v_mfma_f32_16x16x32_bf16 v[64:67], v[144:147], v[100:103], v[64:67]
    ds_read_b128 v[120:123], v13 offset:0
    v_mfma_f32_16x16x32_bf16 v[68:71], v[148:151], v[100:103], v[68:71]
    ds_read_b64_tr_b16 v[156:157], v21 offset:20480
    s_waitcnt lgkmcnt(6)
    v_mfma_f32_16x16x32_bf16 v[72:75], v[144:147], v[104:107], v[72:75]
    ds_read_b64_tr_b16 v[158:159], v21 offset:20992
    v_mfma_f32_16x16x32_bf16 v[76:79], v[148:151], v[104:107], v[76:79]
    ds_read_b128 v[124:127], v13 offset:2048
    s_waitcnt lgkmcnt(7)
    v_mfma_f32_16x16x32_bf16 v[80:83], v[144:147], v[108:111], v[80:83]
    ds_read_b128 v[128:131], v13 offset:4096
    v_mfma_f32_16x16x32_bf16 v[84:87], v[148:151], v[108:111], v[84:87]
    ds_read_b128 v[132:135], v13 offset:6144
    s_waitcnt lgkmcnt(8)
    v_mfma_f32_16x16x32_bf16 v[88:91], v[144:147], v[112:115], v[88:91]
    ds_read_b128 v[136:139], v13 offset:8192
    v_mfma_f32_16x16x32_bf16 v[92:95], v[148:151], v[112:115], v[92:95]
    s_waitcnt lgkmcnt(6)
    v_mfma_f32_16x16x32_bf16 v[56:59], v[152:155], v[120:123], v[56:59]
    ds_read_b64_tr_b16 v[144:145], v20 offset:24576
    s_waitcnt lgkmcnt(5)
    v_mfma_f32_16x16x32_bf16 v[60:63], v[156:159], v[120:123], v[60:63]
    ds_read_b64_tr_b16 v[146:147], v20 offset:25088
    s_waitcnt lgkmcnt(5)
    v_mfma_f32_16x16x32_bf16 v[64:67], v[152:155], v[124:127], v[64:67]
    ds_read_b128 v[96:99], v15 offset:0
    v_mfma_f32_16x16x32_bf16 v[68:71], v[156:159], v[124:127], v[68:71]
    ds_read_b64_tr_b16 v[148:149], v21 offset:24576
    s_waitcnt lgkmcnt(6)
    v_mfma_f32_16x16x32_bf16 v[72:75], v[152:155], v[128:131], v[72:75]
    ds_read_b64_tr_b16 v[150:151], v21 offset:25088
    v_mfma_f32_16x16x32_bf16 v[76:79], v[156:159], v[128:131], v[76:79]
    ds_read_b128 v[100:103], v15 offset:2048
    s_waitcnt lgkmcnt(7)
    v_mfma_f32_16x16x32_bf16 v[80:83], v[152:155], v[132:135], v[80:83]
    ds_read_b128 v[104:107], v15 offset:4096
    v_mfma_f32_16x16x32_bf16 v[84:87], v[156:159], v[132:135], v[84:87]
    ds_read_b128 v[108:111], v15 offset:6144
    s_waitcnt lgkmcnt(8)
    v_mfma_f32_16x16x32_bf16 v[88:91], v[152:155], v[136:139], v[88:91]
    ds_read_b128 v[112:115], v15 offset:8192
    v_mfma_f32_16x16x32_bf16 v[92:95], v[156:159], v[136:139], v[92:95]
    s_waitcnt lgkmcnt(6)
    v_mfma_f32_16x16x32_bf16 v[56:59], v[144:147], v[96:99], v[56:59]
    ds_read_b64_tr_b16 v[152:153], v20 offset:28672
    s_waitcnt lgkmcnt(5)
    v_mfma_f32_16x16x32_bf16 v[60:63], v[148:151], v[96:99], v[60:63]
    ds_read_b64_tr_b16 v[154:155], v20 offset:29184
    s_waitcnt lgkmcnt(5)
    v_mfma_f32_16x16x32_bf16 v[64:67], v[144:147], v[100:103], v[64:67]
    ds_read_b128 v[120:123], v17 offset:0
    v_mfma_f32_16x16x32_bf16 v[68:71], v[148:151], v[100:103], v[68:71]
    ds_read_b64_tr_b16 v[156:157], v21 offset:28672
    s_waitcnt lgkmcnt(6)
    v_mfma_f32_16x16x32_bf16 v[72:75], v[144:147], v[104:107], v[72:75]
    ds_read_b64_tr_b16 v[158:159], v21 offset:29184
    v_mfma_f32_16x16x32_bf16 v[76:79], v[148:151], v[104:107], v[76:79]
    ds_read_b128 v[124:127], v17 offset:2048
    s_waitcnt lgkmcnt(7)
    v_mfma_f32_16x16x32_bf16 v[80:83], v[144:147], v[108:111], v[80:83]
    ds_read_b128 v[128:131], v17 offset:4096
    v_mfma_f32_16x16x32_bf16 v[84:87], v[148:151], v[108:111], v[84:87]
    ds_read_b128 v[132:135], v17 offset:6144
    s_waitcnt lgkmcnt(8)
    v_mfma_f32_16x16x32_bf16 v[88:91], v[144:147], v[112:115], v[88:91]
    ds_read_b128 v[136:139], v17 offset:8192
    v_mfma_f32_16x16x32_bf16 v[92:95], v[148:151], v[112:115], v[92:95]
    s_waitcnt lgkmcnt(0)
    s_barrier
    v_mfma_f32_16x16x32_bf16 v[56:59], v[152:155], v[120:123], v[56:59]
    ds_read_b64_tr_b16 v[144:145], v18 offset:0
    v_mfma_f32_16x16x32_bf16 v[60:63], v[156:159], v[120:123], v[60:63]
    ds_read_b64_tr_b16 v[146:147], v18 offset:512
    v_mfma_f32_16x16x32_bf16 v[64:67], v[152:155], v[124:127], v[64:67]
    ds_read_b128 v[96:99], v12 offset:21504
    v_mfma_f32_16x16x32_bf16 v[68:71], v[156:159], v[124:127], v[68:71]
    ds_read_b64_tr_b16 v[148:149], v19 offset:0
    v_mfma_f32_16x16x32_bf16 v[72:75], v[152:155], v[128:131], v[72:75]
    ds_read_b64_tr_b16 v[150:151], v19 offset:512
    v_mfma_f32_16x16x32_bf16 v[76:79], v[156:159], v[128:131], v[76:79]
    ds_read_b128 v[100:103], v12 offset:23552
    v_mfma_f32_16x16x32_bf16 v[80:83], v[152:155], v[132:135], v[80:83]
    ds_read_b128 v[104:107], v12 offset:25600
    v_mfma_f32_16x16x32_bf16 v[84:87], v[156:159], v[132:135], v[84:87]
    ds_read_b128 v[108:111], v12 offset:27648
    v_mfma_f32_16x16x32_bf16 v[88:91], v[152:155], v[136:139], v[88:91]
    ds_read_b128 v[112:115], v12 offset:29696
    v_mfma_f32_16x16x32_bf16 v[92:95], v[156:159], v[136:139], v[92:95]
    s_waitcnt lgkmcnt(6)
    v_mfma_f32_16x16x32_bf16 v[56:59], v[144:147], v[96:99], v[56:59]
    ds_read_b64_tr_b16 v[152:153], v18 offset:4096
    s_waitcnt lgkmcnt(5)
    v_mfma_f32_16x16x32_bf16 v[60:63], v[148:151], v[96:99], v[60:63]
    ds_read_b64_tr_b16 v[154:155], v18 offset:4608
    s_waitcnt lgkmcnt(5)
    v_mfma_f32_16x16x32_bf16 v[64:67], v[144:147], v[100:103], v[64:67]
    ds_read_b128 v[120:123], v14 offset:21504
    v_mfma_f32_16x16x32_bf16 v[68:71], v[148:151], v[100:103], v[68:71]
    ds_read_b64_tr_b16 v[156:157], v19 offset:4096
    s_waitcnt lgkmcnt(6)
    v_mfma_f32_16x16x32_bf16 v[72:75], v[144:147], v[104:107], v[72:75]
    ds_read_b64_tr_b16 v[158:159], v19 offset:4608
    v_mfma_f32_16x16x32_bf16 v[76:79], v[148:151], v[104:107], v[76:79]
    ds_read_b128 v[124:127], v14 offset:23552
    s_waitcnt lgkmcnt(7)
    v_mfma_f32_16x16x32_bf16 v[80:83], v[144:147], v[108:111], v[80:83]
    ds_read_b128 v[128:131], v14 offset:25600
    v_mfma_f32_16x16x32_bf16 v[84:87], v[148:151], v[108:111], v[84:87]
    ds_read_b128 v[132:135], v14 offset:27648
    s_waitcnt lgkmcnt(8)
    v_mfma_f32_16x16x32_bf16 v[88:91], v[144:147], v[112:115], v[88:91]
    ds_read_b128 v[136:139], v14 offset:29696
    v_mfma_f32_16x16x32_bf16 v[92:95], v[148:151], v[112:115], v[92:95]
    s_waitcnt lgkmcnt(6)
    v_mfma_f32_16x16x32_bf16 v[56:59], v[152:155], v[120:123], v[56:59]
    ds_read_b64_tr_b16 v[144:145], v18 offset:8192
    s_waitcnt lgkmcnt(5)
    v_mfma_f32_16x16x32_bf16 v[60:63], v[156:159], v[120:123], v[60:63]
    ds_read_b64_tr_b16 v[146:147], v18 offset:8704
    s_waitcnt lgkmcnt(5)
    v_mfma_f32_16x16x32_bf16 v[64:67], v[152:155], v[124:127], v[64:67]
    ds_read_b128 v[96:99], v16 offset:21504
    v_mfma_f32_16x16x32_bf16 v[68:71], v[156:159], v[124:127], v[68:71]
    ds_read_b64_tr_b16 v[148:149], v19 offset:8192
    s_waitcnt lgkmcnt(6)
    v_mfma_f32_16x16x32_bf16 v[72:75], v[152:155], v[128:131], v[72:75]
    ds_read_b64_tr_b16 v[150:151], v19 offset:8704
    v_mfma_f32_16x16x32_bf16 v[76:79], v[156:159], v[128:131], v[76:79]
    ds_read_b128 v[100:103], v16 offset:23552
    s_waitcnt lgkmcnt(7)
    v_mfma_f32_16x16x32_bf16 v[80:83], v[152:155], v[132:135], v[80:83]
    ds_read_b128 v[104:107], v16 offset:25600
    v_mfma_f32_16x16x32_bf16 v[84:87], v[156:159], v[132:135], v[84:87]
    ds_read_b128 v[108:111], v16 offset:27648
    s_waitcnt lgkmcnt(8)
    v_mfma_f32_16x16x32_bf16 v[88:91], v[152:155], v[136:139], v[88:91]
    ds_read_b128 v[112:115], v16 offset:29696
    v_mfma_f32_16x16x32_bf16 v[92:95], v[156:159], v[136:139], v[92:95]
    s_waitcnt lgkmcnt(6)
    v_mfma_f32_16x16x32_bf16 v[56:59], v[144:147], v[96:99], v[56:59]
    ds_read_b64_tr_b16 v[152:153], v18 offset:12288
    s_waitcnt lgkmcnt(5)
    v_mfma_f32_16x16x32_bf16 v[60:63], v[148:151], v[96:99], v[60:63]
    ds_read_b64_tr_b16 v[154:155], v18 offset:12800
    s_waitcnt lgkmcnt(5)
    v_mfma_f32_16x16x32_bf16 v[64:67], v[144:147], v[100:103], v[64:67]
    ds_read_b128 v[120:123], v13 offset:21504
    v_mfma_f32_16x16x32_bf16 v[68:71], v[148:151], v[100:103], v[68:71]
    ds_read_b64_tr_b16 v[156:157], v19 offset:12288
    s_waitcnt lgkmcnt(6)
    v_mfma_f32_16x16x32_bf16 v[72:75], v[144:147], v[104:107], v[72:75]
    ds_read_b64_tr_b16 v[158:159], v19 offset:12800
    v_mfma_f32_16x16x32_bf16 v[76:79], v[148:151], v[104:107], v[76:79]
    ds_read_b128 v[124:127], v13 offset:23552
    s_waitcnt lgkmcnt(7)
    v_mfma_f32_16x16x32_bf16 v[80:83], v[144:147], v[108:111], v[80:83]
    ds_read_b128 v[128:131], v13 offset:25600
    v_mfma_f32_16x16x32_bf16 v[84:87], v[148:151], v[108:111], v[84:87]
    ds_read_b128 v[132:135], v13 offset:27648
    s_waitcnt lgkmcnt(8)
    v_mfma_f32_16x16x32_bf16 v[88:91], v[144:147], v[112:115], v[88:91]
    ds_read_b128 v[136:139], v13 offset:29696
    v_mfma_f32_16x16x32_bf16 v[92:95], v[148:151], v[112:115], v[92:95]
    s_waitcnt lgkmcnt(6)
    v_mfma_f32_16x16x32_bf16 v[56:59], v[152:155], v[120:123], v[56:59]
    ds_read_b64_tr_b16 v[144:145], v18 offset:16384
    s_waitcnt lgkmcnt(5)
    v_mfma_f32_16x16x32_bf16 v[60:63], v[156:159], v[120:123], v[60:63]
    ds_read_b64_tr_b16 v[146:147], v18 offset:16896
    s_waitcnt lgkmcnt(5)
    v_mfma_f32_16x16x32_bf16 v[64:67], v[152:155], v[124:127], v[64:67]
    ds_read_b128 v[96:99], v15 offset:21504
    v_mfma_f32_16x16x32_bf16 v[68:71], v[156:159], v[124:127], v[68:71]
    ds_read_b64_tr_b16 v[148:149], v19 offset:16384
    s_waitcnt lgkmcnt(6)
    v_mfma_f32_16x16x32_bf16 v[72:75], v[152:155], v[128:131], v[72:75]
    ds_read_b64_tr_b16 v[150:151], v19 offset:16896
    v_mfma_f32_16x16x32_bf16 v[76:79], v[156:159], v[128:131], v[76:79]
    ds_read_b128 v[100:103], v15 offset:23552
    s_waitcnt lgkmcnt(7)
    v_mfma_f32_16x16x32_bf16 v[80:83], v[152:155], v[132:135], v[80:83]
    ds_read_b128 v[104:107], v15 offset:25600
    v_mfma_f32_16x16x32_bf16 v[84:87], v[156:159], v[132:135], v[84:87]
    ds_read_b128 v[108:111], v15 offset:27648
    s_waitcnt lgkmcnt(8)
    v_mfma_f32_16x16x32_bf16 v[88:91], v[152:155], v[136:139], v[88:91]
    ds_read_b128 v[112:115], v15 offset:29696
    v_mfma_f32_16x16x32_bf16 v[92:95], v[156:159], v[136:139], v[92:95]
    s_waitcnt lgkmcnt(6)
    v_mfma_f32_16x16x32_bf16 v[56:59], v[144:147], v[96:99], v[56:59]
    ds_read_b64_tr_b16 v[152:153], v18 offset:20480
    s_waitcnt lgkmcnt(5)
    v_mfma_f32_16x16x32_bf16 v[60:63], v[148:151], v[96:99], v[60:63]
    ds_read_b64_tr_b16 v[154:155], v18 offset:20992
    s_waitcnt lgkmcnt(5)
    v_mfma_f32_16x16x32_bf16 v[64:67], v[144:147], v[100:103], v[64:67]
    ds_read_b128 v[120:123], v17 offset:21504
    v_mfma_f32_16x16x32_bf16 v[68:71], v[148:151], v[100:103], v[68:71]
    ds_read_b64_tr_b16 v[156:157], v19 offset:20480
    s_waitcnt lgkmcnt(6)
    v_mfma_f32_16x16x32_bf16 v[72:75], v[144:147], v[104:107], v[72:75]
    ds_read_b64_tr_b16 v[158:159], v19 offset:20992
    v_mfma_f32_16x16x32_bf16 v[76:79], v[148:151], v[104:107], v[76:79]
    ds_read_b128 v[124:127], v17 offset:23552
    s_waitcnt lgkmcnt(7)
    v_mfma_f32_16x16x32_bf16 v[80:83], v[144:147], v[108:111], v[80:83]
    ds_read_b128 v[128:131], v17 offset:25600
    v_mfma_f32_16x16x32_bf16 v[84:87], v[148:151], v[108:111], v[84:87]
    ds_read_b128 v[132:135], v17 offset:27648
    s_waitcnt lgkmcnt(8)
    v_mfma_f32_16x16x32_bf16 v[88:91], v[144:147], v[112:115], v[88:91]
    ds_read_b128 v[136:139], v17 offset:29696
    v_mfma_f32_16x16x32_bf16 v[92:95], v[148:151], v[112:115], v[92:95]
    s_waitcnt lgkmcnt(0)
    s_barrier
    v_mfma_f32_16x16x32_bf16 v[56:59], v[152:155], v[120:123], v[56:59]
    ds_read_b64_tr_b16 v[144:145], v18 offset:24576
    v_mfma_f32_16x16x32_bf16 v[60:63], v[156:159], v[120:123], v[60:63]
    ds_read_b64_tr_b16 v[146:147], v18 offset:25088
    v_mfma_f32_16x16x32_bf16 v[64:67], v[152:155], v[124:127], v[64:67]
    ds_read_b128 v[96:99], v12 offset:43008
    v_mfma_f32_16x16x32_bf16 v[68:71], v[156:159], v[124:127], v[68:71]
    ds_read_b64_tr_b16 v[148:149], v19 offset:24576
    v_mfma_f32_16x16x32_bf16 v[72:75], v[152:155], v[128:131], v[72:75]
    ds_read_b64_tr_b16 v[150:151], v19 offset:25088
    v_mfma_f32_16x16x32_bf16 v[76:79], v[156:159], v[128:131], v[76:79]
    ds_read_b128 v[100:103], v12 offset:45056
    v_mfma_f32_16x16x32_bf16 v[80:83], v[152:155], v[132:135], v[80:83]
    ds_read_b128 v[104:107], v12 offset:47104
    v_mfma_f32_16x16x32_bf16 v[84:87], v[156:159], v[132:135], v[84:87]
    ds_read_b128 v[108:111], v12 offset:49152
    v_mfma_f32_16x16x32_bf16 v[88:91], v[152:155], v[136:139], v[88:91]
    ds_read_b128 v[112:115], v12 offset:51200
    v_mfma_f32_16x16x32_bf16 v[92:95], v[156:159], v[136:139], v[92:95]
    s_waitcnt lgkmcnt(6)
    v_mfma_f32_16x16x32_bf16 v[56:59], v[144:147], v[96:99], v[56:59]
    ds_read_b64_tr_b16 v[152:153], v18 offset:28672
    s_waitcnt lgkmcnt(5)
    v_mfma_f32_16x16x32_bf16 v[60:63], v[148:151], v[96:99], v[60:63]
    ds_read_b64_tr_b16 v[154:155], v18 offset:29184
    s_waitcnt lgkmcnt(5)
    v_mfma_f32_16x16x32_bf16 v[64:67], v[144:147], v[100:103], v[64:67]
    ds_read_b128 v[120:123], v14 offset:43008
    v_mfma_f32_16x16x32_bf16 v[68:71], v[148:151], v[100:103], v[68:71]
    ds_read_b64_tr_b16 v[156:157], v19 offset:28672
    s_waitcnt lgkmcnt(6)
    v_mfma_f32_16x16x32_bf16 v[72:75], v[144:147], v[104:107], v[72:75]
    ds_read_b64_tr_b16 v[158:159], v19 offset:29184
    v_mfma_f32_16x16x32_bf16 v[76:79], v[148:151], v[104:107], v[76:79]
    ds_read_b128 v[124:127], v14 offset:45056
    s_waitcnt lgkmcnt(7)
    v_mfma_f32_16x16x32_bf16 v[80:83], v[144:147], v[108:111], v[80:83]
    ds_read_b128 v[128:131], v14 offset:47104
    v_mfma_f32_16x16x32_bf16 v[84:87], v[148:151], v[108:111], v[84:87]
    ds_read_b128 v[132:135], v14 offset:49152
    s_waitcnt lgkmcnt(8)
    v_mfma_f32_16x16x32_bf16 v[88:91], v[144:147], v[112:115], v[88:91]
    ds_read_b128 v[136:139], v14 offset:51200
    v_mfma_f32_16x16x32_bf16 v[92:95], v[148:151], v[112:115], v[92:95]
    s_waitcnt lgkmcnt(6)
    v_mfma_f32_16x16x32_bf16 v[56:59], v[152:155], v[120:123], v[56:59]
    ds_read_b64_tr_b16 v[144:145], v18 offset:32768
    s_waitcnt lgkmcnt(5)
    v_mfma_f32_16x16x32_bf16 v[60:63], v[156:159], v[120:123], v[60:63]
    ds_read_b64_tr_b16 v[146:147], v18 offset:33280
    s_waitcnt lgkmcnt(5)
    v_mfma_f32_16x16x32_bf16 v[64:67], v[152:155], v[124:127], v[64:67]
    ds_read_b128 v[96:99], v16 offset:43008
    v_mfma_f32_16x16x32_bf16 v[68:71], v[156:159], v[124:127], v[68:71]
    ds_read_b64_tr_b16 v[148:149], v19 offset:32768
    s_waitcnt lgkmcnt(6)
    v_mfma_f32_16x16x32_bf16 v[72:75], v[152:155], v[128:131], v[72:75]
    ds_read_b64_tr_b16 v[150:151], v19 offset:33280
    v_mfma_f32_16x16x32_bf16 v[76:79], v[156:159], v[128:131], v[76:79]
    ds_read_b128 v[100:103], v16 offset:45056
    s_waitcnt lgkmcnt(7)
    v_mfma_f32_16x16x32_bf16 v[80:83], v[152:155], v[132:135], v[80:83]
    ds_read_b128 v[104:107], v16 offset:47104
    v_mfma_f32_16x16x32_bf16 v[84:87], v[156:159], v[132:135], v[84:87]
    ds_read_b128 v[108:111], v16 offset:49152
    s_waitcnt lgkmcnt(8)
    v_mfma_f32_16x16x32_bf16 v[88:91], v[152:155], v[136:139], v[88:91]
    ds_read_b128 v[112:115], v16 offset:51200
    v_mfma_f32_16x16x32_bf16 v[92:95], v[156:159], v[136:139], v[92:95]
    s_waitcnt lgkmcnt(6)
    v_mfma_f32_16x16x32_bf16 v[56:59], v[144:147], v[96:99], v[56:59]
    ds_read_b64_tr_b16 v[152:153], v18 offset:36864
    s_waitcnt lgkmcnt(5)
    v_mfma_f32_16x16x32_bf16 v[60:63], v[148:151], v[96:99], v[60:63]
    ds_read_b64_tr_b16 v[154:155], v18 offset:37376
    s_waitcnt lgkmcnt(5)
    v_mfma_f32_16x16x32_bf16 v[64:67], v[144:147], v[100:103], v[64:67]
    ds_read_b128 v[120:123], v13 offset:43008
    v_mfma_f32_16x16x32_bf16 v[68:71], v[148:151], v[100:103], v[68:71]
    ds_read_b64_tr_b16 v[156:157], v19 offset:36864
    s_waitcnt lgkmcnt(6)
    v_mfma_f32_16x16x32_bf16 v[72:75], v[144:147], v[104:107], v[72:75]
    ds_read_b64_tr_b16 v[158:159], v19 offset:37376
    v_mfma_f32_16x16x32_bf16 v[76:79], v[148:151], v[104:107], v[76:79]
    ds_read_b128 v[124:127], v13 offset:45056
    s_waitcnt lgkmcnt(7)
    v_mfma_f32_16x16x32_bf16 v[80:83], v[144:147], v[108:111], v[80:83]
    ds_read_b128 v[128:131], v13 offset:47104
    v_mfma_f32_16x16x32_bf16 v[84:87], v[148:151], v[108:111], v[84:87]
    ds_read_b128 v[132:135], v13 offset:49152
    s_waitcnt lgkmcnt(8)
    v_mfma_f32_16x16x32_bf16 v[88:91], v[144:147], v[112:115], v[88:91]
    ds_read_b128 v[136:139], v13 offset:51200
    v_mfma_f32_16x16x32_bf16 v[92:95], v[148:151], v[112:115], v[92:95]
    s_waitcnt lgkmcnt(6)
    v_mfma_f32_16x16x32_bf16 v[56:59], v[152:155], v[120:123], v[56:59]
    ds_read_b64_tr_b16 v[144:145], v18 offset:40960
    s_waitcnt lgkmcnt(5)
    v_mfma_f32_16x16x32_bf16 v[60:63], v[156:159], v[120:123], v[60:63]
    ds_read_b64_tr_b16 v[146:147], v18 offset:41472
    s_waitcnt lgkmcnt(5)
    v_mfma_f32_16x16x32_bf16 v[64:67], v[152:155], v[124:127], v[64:67]
    ds_read_b128 v[96:99], v15 offset:43008
    v_mfma_f32_16x16x32_bf16 v[68:71], v[156:159], v[124:127], v[68:71]
    ds_read_b64_tr_b16 v[148:149], v19 offset:40960
    s_waitcnt lgkmcnt(6)
    v_mfma_f32_16x16x32_bf16 v[72:75], v[152:155], v[128:131], v[72:75]
    ds_read_b64_tr_b16 v[150:151], v19 offset:41472
    v_mfma_f32_16x16x32_bf16 v[76:79], v[156:159], v[128:131], v[76:79]
    ds_read_b128 v[100:103], v15 offset:45056
    s_waitcnt lgkmcnt(7)
    v_mfma_f32_16x16x32_bf16 v[80:83], v[152:155], v[132:135], v[80:83]
    ds_read_b128 v[104:107], v15 offset:47104
    v_mfma_f32_16x16x32_bf16 v[84:87], v[156:159], v[132:135], v[84:87]
    ds_read_b128 v[108:111], v15 offset:49152
    s_waitcnt lgkmcnt(8)
    v_mfma_f32_16x16x32_bf16 v[88:91], v[152:155], v[136:139], v[88:91]
    ds_read_b128 v[112:115], v15 offset:51200
    v_mfma_f32_16x16x32_bf16 v[92:95], v[156:159], v[136:139], v[92:95]
    s_waitcnt lgkmcnt(6)
    v_mfma_f32_16x16x32_bf16 v[56:59], v[144:147], v[96:99], v[56:59]
    ds_read_b64_tr_b16 v[152:153], v18 offset:45056
    s_waitcnt lgkmcnt(5)
    v_mfma_f32_16x16x32_bf16 v[60:63], v[148:151], v[96:99], v[60:63]
    ds_read_b64_tr_b16 v[154:155], v18 offset:45568
    s_waitcnt lgkmcnt(5)
    v_mfma_f32_16x16x32_bf16 v[64:67], v[144:147], v[100:103], v[64:67]
    ds_read_b128 v[120:123], v17 offset:43008
    v_mfma_f32_16x16x32_bf16 v[68:71], v[148:151], v[100:103], v[68:71]
    ds_read_b64_tr_b16 v[156:157], v19 offset:45056
    s_waitcnt lgkmcnt(6)
    v_mfma_f32_16x16x32_bf16 v[72:75], v[144:147], v[104:107], v[72:75]
    ds_read_b64_tr_b16 v[158:159], v19 offset:45568
    v_mfma_f32_16x16x32_bf16 v[76:79], v[148:151], v[104:107], v[76:79]
    ds_read_b128 v[124:127], v17 offset:45056
    s_waitcnt lgkmcnt(7)
    v_mfma_f32_16x16x32_bf16 v[80:83], v[144:147], v[108:111], v[80:83]
    ds_read_b128 v[128:131], v17 offset:47104
    v_mfma_f32_16x16x32_bf16 v[84:87], v[148:151], v[108:111], v[84:87]
    ds_read_b128 v[132:135], v17 offset:49152
    s_waitcnt lgkmcnt(8)
    v_mfma_f32_16x16x32_bf16 v[88:91], v[144:147], v[112:115], v[88:91]
    ds_read_b128 v[136:139], v17 offset:51200
    v_mfma_f32_16x16x32_bf16 v[92:95], v[148:151], v[112:115], v[92:95]
    s_waitcnt lgkmcnt(0)
    s_barrier
    v_mfma_f32_16x16x32_bf16 v[56:59], v[152:155], v[120:123], v[56:59]
    ds_read_b64_tr_b16 v[144:145], v18 offset:49152
    v_mfma_f32_16x16x32_bf16 v[60:63], v[156:159], v[120:123], v[60:63]
    ds_read_b64_tr_b16 v[146:147], v18 offset:49664
    v_mfma_f32_16x16x32_bf16 v[64:67], v[152:155], v[124:127], v[64:67]
    ds_read_b128 v[96:99], v12 offset:0
    v_mfma_f32_16x16x32_bf16 v[68:71], v[156:159], v[124:127], v[68:71]
    ds_read_b64_tr_b16 v[148:149], v19 offset:49152
    v_mfma_f32_16x16x32_bf16 v[72:75], v[152:155], v[128:131], v[72:75]
    ds_read_b64_tr_b16 v[150:151], v19 offset:49664
    v_mfma_f32_16x16x32_bf16 v[76:79], v[156:159], v[128:131], v[76:79]
    ds_read_b128 v[100:103], v12 offset:2048
    v_mfma_f32_16x16x32_bf16 v[80:83], v[152:155], v[132:135], v[80:83]
    ds_read_b128 v[104:107], v12 offset:4096
    v_mfma_f32_16x16x32_bf16 v[84:87], v[156:159], v[132:135], v[84:87]
    ds_read_b128 v[108:111], v12 offset:6144
    v_mfma_f32_16x16x32_bf16 v[88:91], v[152:155], v[136:139], v[88:91]
    ds_read_b128 v[112:115], v12 offset:8192
    v_mfma_f32_16x16x32_bf16 v[92:95], v[156:159], v[136:139], v[92:95]
    s_waitcnt lgkmcnt(6)
    v_mfma_f32_16x16x32_bf16 v[56:59], v[144:147], v[96:99], v[56:59]
    ds_read_b64_tr_b16 v[152:153], v18 offset:53248
    s_waitcnt lgkmcnt(5)
    v_mfma_f32_16x16x32_bf16 v[60:63], v[148:151], v[96:99], v[60:63]
    ds_read_b64_tr_b16 v[154:155], v18 offset:53760
    s_waitcnt lgkmcnt(5)
    v_mfma_f32_16x16x32_bf16 v[64:67], v[144:147], v[100:103], v[64:67]
    ds_read_b128 v[120:123], v14 offset:0
    v_mfma_f32_16x16x32_bf16 v[68:71], v[148:151], v[100:103], v[68:71]
    ds_read_b64_tr_b16 v[156:157], v19 offset:53248
    s_waitcnt lgkmcnt(6)
    v_mfma_f32_16x16x32_bf16 v[72:75], v[144:147], v[104:107], v[72:75]
    ds_read_b64_tr_b16 v[158:159], v19 offset:53760
    v_mfma_f32_16x16x32_bf16 v[76:79], v[148:151], v[104:107], v[76:79]
    ds_read_b128 v[124:127], v14 offset:2048
    s_waitcnt lgkmcnt(7)
    v_mfma_f32_16x16x32_bf16 v[80:83], v[144:147], v[108:111], v[80:83]
    ds_read_b128 v[128:131], v14 offset:4096
    v_mfma_f32_16x16x32_bf16 v[84:87], v[148:151], v[108:111], v[84:87]
    ds_read_b128 v[132:135], v14 offset:6144
    s_waitcnt lgkmcnt(8)
    v_mfma_f32_16x16x32_bf16 v[88:91], v[144:147], v[112:115], v[88:91]
    ds_read_b128 v[136:139], v14 offset:8192
    v_mfma_f32_16x16x32_bf16 v[92:95], v[148:151], v[112:115], v[92:95]
    s_waitcnt lgkmcnt(6)
    v_mfma_f32_16x16x32_bf16 v[56:59], v[152:155], v[120:123], v[56:59]
    ds_read_b64_tr_b16 v[144:145], v18 offset:57344
    s_waitcnt lgkmcnt(5)
    v_mfma_f32_16x16x32_bf16 v[60:63], v[156:159], v[120:123], v[60:63]
    ds_read_b64_tr_b16 v[146:147], v18 offset:57856
    s_waitcnt lgkmcnt(5)
    v_mfma_f32_16x16x32_bf16 v[64:67], v[152:155], v[124:127], v[64:67]
    ds_read_b128 v[96:99], v16 offset:0
    v_mfma_f32_16x16x32_bf16 v[68:71], v[156:159], v[124:127], v[68:71]
    ds_read_b64_tr_b16 v[148:149], v19 offset:57344
    s_waitcnt lgkmcnt(6)
    v_mfma_f32_16x16x32_bf16 v[72:75], v[152:155], v[128:131], v[72:75]
    ds_read_b64_tr_b16 v[150:151], v19 offset:57856
    v_mfma_f32_16x16x32_bf16 v[76:79], v[156:159], v[128:131], v[76:79]
    ds_read_b128 v[100:103], v16 offset:2048
    s_waitcnt lgkmcnt(7)
    v_mfma_f32_16x16x32_bf16 v[80:83], v[152:155], v[132:135], v[80:83]
    ds_read_b128 v[104:107], v16 offset:4096
    v_mfma_f32_16x16x32_bf16 v[84:87], v[156:159], v[132:135], v[84:87]
    ds_read_b128 v[108:111], v16 offset:6144
    s_waitcnt lgkmcnt(8)
    v_mfma_f32_16x16x32_bf16 v[88:91], v[152:155], v[136:139], v[88:91]
    ds_read_b128 v[112:115], v16 offset:8192
    v_mfma_f32_16x16x32_bf16 v[92:95], v[156:159], v[136:139], v[92:95]
    s_waitcnt lgkmcnt(6)
    v_mfma_f32_16x16x32_bf16 v[56:59], v[144:147], v[96:99], v[56:59]
    ds_read_b64_tr_b16 v[152:153], v18 offset:61440
    s_waitcnt lgkmcnt(5)
    v_mfma_f32_16x16x32_bf16 v[60:63], v[148:151], v[96:99], v[60:63]
    ds_read_b64_tr_b16 v[154:155], v18 offset:61952
    s_waitcnt lgkmcnt(5)
    v_mfma_f32_16x16x32_bf16 v[64:67], v[144:147], v[100:103], v[64:67]
    ds_read_b128 v[120:123], v13 offset:0
    v_mfma_f32_16x16x32_bf16 v[68:71], v[148:151], v[100:103], v[68:71]
    ds_read_b64_tr_b16 v[156:157], v19 offset:61440
    s_waitcnt lgkmcnt(6)
    v_mfma_f32_16x16x32_bf16 v[72:75], v[144:147], v[104:107], v[72:75]
    ds_read_b64_tr_b16 v[158:159], v19 offset:61952
    v_mfma_f32_16x16x32_bf16 v[76:79], v[148:151], v[104:107], v[76:79]
    ds_read_b128 v[124:127], v13 offset:2048
    s_waitcnt lgkmcnt(7)
    v_mfma_f32_16x16x32_bf16 v[80:83], v[144:147], v[108:111], v[80:83]
    ds_read_b128 v[128:131], v13 offset:4096
    v_mfma_f32_16x16x32_bf16 v[84:87], v[148:151], v[108:111], v[84:87]
    ds_read_b128 v[132:135], v13 offset:6144
    s_waitcnt lgkmcnt(8)
    v_mfma_f32_16x16x32_bf16 v[88:91], v[144:147], v[112:115], v[88:91]
    ds_read_b128 v[136:139], v13 offset:8192
    v_mfma_f32_16x16x32_bf16 v[92:95], v[148:151], v[112:115], v[92:95]
    s_waitcnt lgkmcnt(6)
    v_mfma_f32_16x16x32_bf16 v[56:59], v[152:155], v[120:123], v[56:59]
    ds_read_b64_tr_b16 v[144:145], v20 offset:0
    s_waitcnt lgkmcnt(5)
    v_mfma_f32_16x16x32_bf16 v[60:63], v[156:159], v[120:123], v[60:63]
    ds_read_b64_tr_b16 v[146:147], v20 offset:512
    s_waitcnt lgkmcnt(5)
    v_mfma_f32_16x16x32_bf16 v[64:67], v[152:155], v[124:127], v[64:67]
    ds_read_b128 v[96:99], v15 offset:0
    v_mfma_f32_16x16x32_bf16 v[68:71], v[156:159], v[124:127], v[68:71]
    ds_read_b64_tr_b16 v[148:149], v21 offset:0
    s_waitcnt lgkmcnt(6)
    v_mfma_f32_16x16x32_bf16 v[72:75], v[152:155], v[128:131], v[72:75]
    ds_read_b64_tr_b16 v[150:151], v21 offset:512
    v_mfma_f32_16x16x32_bf16 v[76:79], v[156:159], v[128:131], v[76:79]
    ds_read_b128 v[100:103], v15 offset:2048
    s_waitcnt lgkmcnt(7)
    v_mfma_f32_16x16x32_bf16 v[80:83], v[152:155], v[132:135], v[80:83]
    ds_read_b128 v[104:107], v15 offset:4096
    v_mfma_f32_16x16x32_bf16 v[84:87], v[156:159], v[132:135], v[84:87]
    ds_read_b128 v[108:111], v15 offset:6144
    s_waitcnt lgkmcnt(8)
    v_mfma_f32_16x16x32_bf16 v[88:91], v[152:155], v[136:139], v[88:91]
    ds_read_b128 v[112:115], v15 offset:8192
    v_mfma_f32_16x16x32_bf16 v[92:95], v[156:159], v[136:139], v[92:95]
    s_waitcnt lgkmcnt(6)
    v_mfma_f32_16x16x32_bf16 v[56:59], v[144:147], v[96:99], v[56:59]
    ds_read_b64_tr_b16 v[152:153], v20 offset:4096
    s_waitcnt lgkmcnt(5)
    v_mfma_f32_16x16x32_bf16 v[60:63], v[148:151], v[96:99], v[60:63]
    ds_read_b64_tr_b16 v[154:155], v20 offset:4608
    s_waitcnt lgkmcnt(5)
    v_mfma_f32_16x16x32_bf16 v[64:67], v[144:147], v[100:103], v[64:67]
    ds_read_b128 v[120:123], v17 offset:0
    v_mfma_f32_16x16x32_bf16 v[68:71], v[148:151], v[100:103], v[68:71]
    ds_read_b64_tr_b16 v[156:157], v21 offset:4096
    s_waitcnt lgkmcnt(6)
    v_mfma_f32_16x16x32_bf16 v[72:75], v[144:147], v[104:107], v[72:75]
    ds_read_b64_tr_b16 v[158:159], v21 offset:4608
    v_mfma_f32_16x16x32_bf16 v[76:79], v[148:151], v[104:107], v[76:79]
    ds_read_b128 v[124:127], v17 offset:2048
    s_waitcnt lgkmcnt(7)
    v_mfma_f32_16x16x32_bf16 v[80:83], v[144:147], v[108:111], v[80:83]
    ds_read_b128 v[128:131], v17 offset:4096
    v_mfma_f32_16x16x32_bf16 v[84:87], v[148:151], v[108:111], v[84:87]
    ds_read_b128 v[132:135], v17 offset:6144
    s_waitcnt lgkmcnt(8)
    v_mfma_f32_16x16x32_bf16 v[88:91], v[144:147], v[112:115], v[88:91]
    ds_read_b128 v[136:139], v17 offset:8192
    v_mfma_f32_16x16x32_bf16 v[92:95], v[148:151], v[112:115], v[92:95]
    s_waitcnt lgkmcnt(0)
    s_barrier
    v_mfma_f32_16x16x32_bf16 v[56:59], v[152:155], v[120:123], v[56:59]
    ds_read_b64_tr_b16 v[144:145], v20 offset:8192
    v_mfma_f32_16x16x32_bf16 v[60:63], v[156:159], v[120:123], v[60:63]
    ds_read_b64_tr_b16 v[146:147], v20 offset:8704
    v_mfma_f32_16x16x32_bf16 v[64:67], v[152:155], v[124:127], v[64:67]
    ds_read_b128 v[96:99], v12 offset:21504
    v_mfma_f32_16x16x32_bf16 v[68:71], v[156:159], v[124:127], v[68:71]
    ds_read_b64_tr_b16 v[148:149], v21 offset:8192
    v_mfma_f32_16x16x32_bf16 v[72:75], v[152:155], v[128:131], v[72:75]
    ds_read_b64_tr_b16 v[150:151], v21 offset:8704
    v_mfma_f32_16x16x32_bf16 v[76:79], v[156:159], v[128:131], v[76:79]
    ds_read_b128 v[100:103], v12 offset:23552
    v_mfma_f32_16x16x32_bf16 v[80:83], v[152:155], v[132:135], v[80:83]
    ds_read_b128 v[104:107], v12 offset:25600
    v_mfma_f32_16x16x32_bf16 v[84:87], v[156:159], v[132:135], v[84:87]
    ds_read_b128 v[108:111], v12 offset:27648
    v_mfma_f32_16x16x32_bf16 v[88:91], v[152:155], v[136:139], v[88:91]
    ds_read_b128 v[112:115], v12 offset:29696
    v_mfma_f32_16x16x32_bf16 v[92:95], v[156:159], v[136:139], v[92:95]
    s_waitcnt lgkmcnt(6)
    v_mfma_f32_16x16x32_bf16 v[56:59], v[144:147], v[96:99], v[56:59]
    ds_read_b64_tr_b16 v[152:153], v20 offset:12288
    s_waitcnt lgkmcnt(5)
    v_mfma_f32_16x16x32_bf16 v[60:63], v[148:151], v[96:99], v[60:63]
    ds_read_b64_tr_b16 v[154:155], v20 offset:12800
    s_waitcnt lgkmcnt(5)
    v_mfma_f32_16x16x32_bf16 v[64:67], v[144:147], v[100:103], v[64:67]
    ds_read_b128 v[120:123], v14 offset:21504
    v_mfma_f32_16x16x32_bf16 v[68:71], v[148:151], v[100:103], v[68:71]
    ds_read_b64_tr_b16 v[156:157], v21 offset:12288
    s_waitcnt lgkmcnt(6)
    v_mfma_f32_16x16x32_bf16 v[72:75], v[144:147], v[104:107], v[72:75]
    ds_read_b64_tr_b16 v[158:159], v21 offset:12800
    v_mfma_f32_16x16x32_bf16 v[76:79], v[148:151], v[104:107], v[76:79]
    ds_read_b128 v[124:127], v14 offset:23552
    s_waitcnt lgkmcnt(7)
    v_mfma_f32_16x16x32_bf16 v[80:83], v[144:147], v[108:111], v[80:83]
    ds_read_b128 v[128:131], v14 offset:25600
    v_mfma_f32_16x16x32_bf16 v[84:87], v[148:151], v[108:111], v[84:87]
    ds_read_b128 v[132:135], v14 offset:27648
    s_waitcnt lgkmcnt(8)
    v_mfma_f32_16x16x32_bf16 v[88:91], v[144:147], v[112:115], v[88:91]
    ds_read_b128 v[136:139], v14 offset:29696
    v_mfma_f32_16x16x32_bf16 v[92:95], v[148:151], v[112:115], v[92:95]
    s_waitcnt lgkmcnt(6)
    v_mfma_f32_16x16x32_bf16 v[56:59], v[152:155], v[120:123], v[56:59]
    ds_read_b64_tr_b16 v[144:145], v20 offset:16384
    s_waitcnt lgkmcnt(5)
    v_mfma_f32_16x16x32_bf16 v[60:63], v[156:159], v[120:123], v[60:63]
    ds_read_b64_tr_b16 v[146:147], v20 offset:16896
    s_waitcnt lgkmcnt(5)
    v_mfma_f32_16x16x32_bf16 v[64:67], v[152:155], v[124:127], v[64:67]
    ds_read_b128 v[96:99], v16 offset:21504
    v_mfma_f32_16x16x32_bf16 v[68:71], v[156:159], v[124:127], v[68:71]
    ds_read_b64_tr_b16 v[148:149], v21 offset:16384
    s_waitcnt lgkmcnt(6)
    v_mfma_f32_16x16x32_bf16 v[72:75], v[152:155], v[128:131], v[72:75]
    ds_read_b64_tr_b16 v[150:151], v21 offset:16896
    v_mfma_f32_16x16x32_bf16 v[76:79], v[156:159], v[128:131], v[76:79]
    ds_read_b128 v[100:103], v16 offset:23552
    s_waitcnt lgkmcnt(7)
    v_mfma_f32_16x16x32_bf16 v[80:83], v[152:155], v[132:135], v[80:83]
    ds_read_b128 v[104:107], v16 offset:25600
    v_mfma_f32_16x16x32_bf16 v[84:87], v[156:159], v[132:135], v[84:87]
    ds_read_b128 v[108:111], v16 offset:27648
    s_waitcnt lgkmcnt(8)
    v_mfma_f32_16x16x32_bf16 v[88:91], v[152:155], v[136:139], v[88:91]
    ds_read_b128 v[112:115], v16 offset:29696
    v_mfma_f32_16x16x32_bf16 v[92:95], v[156:159], v[136:139], v[92:95]
    s_waitcnt lgkmcnt(6)
    v_mfma_f32_16x16x32_bf16 v[56:59], v[144:147], v[96:99], v[56:59]
    ds_read_b64_tr_b16 v[152:153], v20 offset:20480
    s_waitcnt lgkmcnt(5)
    v_mfma_f32_16x16x32_bf16 v[60:63], v[148:151], v[96:99], v[60:63]
    ds_read_b64_tr_b16 v[154:155], v20 offset:20992
    s_waitcnt lgkmcnt(5)
    v_mfma_f32_16x16x32_bf16 v[64:67], v[144:147], v[100:103], v[64:67]
    ds_read_b128 v[120:123], v13 offset:21504
    v_mfma_f32_16x16x32_bf16 v[68:71], v[148:151], v[100:103], v[68:71]
    ds_read_b64_tr_b16 v[156:157], v21 offset:20480
    s_waitcnt lgkmcnt(6)
    v_mfma_f32_16x16x32_bf16 v[72:75], v[144:147], v[104:107], v[72:75]
    ds_read_b64_tr_b16 v[158:159], v21 offset:20992
    v_mfma_f32_16x16x32_bf16 v[76:79], v[148:151], v[104:107], v[76:79]
    ds_read_b128 v[124:127], v13 offset:23552
    s_waitcnt lgkmcnt(7)
    v_mfma_f32_16x16x32_bf16 v[80:83], v[144:147], v[108:111], v[80:83]
    ds_read_b128 v[128:131], v13 offset:25600
    v_mfma_f32_16x16x32_bf16 v[84:87], v[148:151], v[108:111], v[84:87]
    ds_read_b128 v[132:135], v13 offset:27648
    s_waitcnt lgkmcnt(8)
    v_mfma_f32_16x16x32_bf16 v[88:91], v[144:147], v[112:115], v[88:91]
    ds_read_b128 v[136:139], v13 offset:29696
    v_mfma_f32_16x16x32_bf16 v[92:95], v[148:151], v[112:115], v[92:95]
    s_waitcnt lgkmcnt(6)
    v_mfma_f32_16x16x32_bf16 v[56:59], v[152:155], v[120:123], v[56:59]
    ds_read_b64_tr_b16 v[144:145], v20 offset:24576
    s_waitcnt lgkmcnt(5)
    v_mfma_f32_16x16x32_bf16 v[60:63], v[156:159], v[120:123], v[60:63]
    ds_read_b64_tr_b16 v[146:147], v20 offset:25088
    s_waitcnt lgkmcnt(5)
    v_mfma_f32_16x16x32_bf16 v[64:67], v[152:155], v[124:127], v[64:67]
    ds_read_b128 v[96:99], v15 offset:21504
    v_mfma_f32_16x16x32_bf16 v[68:71], v[156:159], v[124:127], v[68:71]
    ds_read_b64_tr_b16 v[148:149], v21 offset:24576
    s_waitcnt lgkmcnt(6)
    v_mfma_f32_16x16x32_bf16 v[72:75], v[152:155], v[128:131], v[72:75]
    ds_read_b64_tr_b16 v[150:151], v21 offset:25088
    v_mfma_f32_16x16x32_bf16 v[76:79], v[156:159], v[128:131], v[76:79]
    ds_read_b128 v[100:103], v15 offset:23552
    s_waitcnt lgkmcnt(7)
    v_mfma_f32_16x16x32_bf16 v[80:83], v[152:155], v[132:135], v[80:83]
    ds_read_b128 v[104:107], v15 offset:25600
    v_mfma_f32_16x16x32_bf16 v[84:87], v[156:159], v[132:135], v[84:87]
    ds_read_b128 v[108:111], v15 offset:27648
    s_waitcnt lgkmcnt(8)
    v_mfma_f32_16x16x32_bf16 v[88:91], v[152:155], v[136:139], v[88:91]
    ds_read_b128 v[112:115], v15 offset:29696
    v_mfma_f32_16x16x32_bf16 v[92:95], v[156:159], v[136:139], v[92:95]
    s_waitcnt lgkmcnt(6)
    v_mfma_f32_16x16x32_bf16 v[56:59], v[144:147], v[96:99], v[56:59]
    ds_read_b64_tr_b16 v[152:153], v20 offset:28672
    s_waitcnt lgkmcnt(5)
    v_mfma_f32_16x16x32_bf16 v[60:63], v[148:151], v[96:99], v[60:63]
    ds_read_b64_tr_b16 v[154:155], v20 offset:29184
    s_waitcnt lgkmcnt(5)
    v_mfma_f32_16x16x32_bf16 v[64:67], v[144:147], v[100:103], v[64:67]
    ds_read_b128 v[120:123], v17 offset:21504
    v_mfma_f32_16x16x32_bf16 v[68:71], v[148:151], v[100:103], v[68:71]
    ds_read_b64_tr_b16 v[156:157], v21 offset:28672
    s_waitcnt lgkmcnt(6)
    v_mfma_f32_16x16x32_bf16 v[72:75], v[144:147], v[104:107], v[72:75]
    ds_read_b64_tr_b16 v[158:159], v21 offset:29184
    v_mfma_f32_16x16x32_bf16 v[76:79], v[148:151], v[104:107], v[76:79]
    ds_read_b128 v[124:127], v17 offset:23552
    s_waitcnt lgkmcnt(7)
    v_mfma_f32_16x16x32_bf16 v[80:83], v[144:147], v[108:111], v[80:83]
    ds_read_b128 v[128:131], v17 offset:25600
    v_mfma_f32_16x16x32_bf16 v[84:87], v[148:151], v[108:111], v[84:87]
    ds_read_b128 v[132:135], v17 offset:27648
    s_waitcnt lgkmcnt(8)
    v_mfma_f32_16x16x32_bf16 v[88:91], v[144:147], v[112:115], v[88:91]
    ds_read_b128 v[136:139], v17 offset:29696
    v_mfma_f32_16x16x32_bf16 v[92:95], v[148:151], v[112:115], v[92:95]
    s_waitcnt lgkmcnt(0)
    s_barrier
    v_mfma_f32_16x16x32_bf16 v[56:59], v[152:155], v[120:123], v[56:59]
    ds_read_b64_tr_b16 v[160:161], v18 offset:0
    ds_read_b64_tr_b16 v[162:163], v18 offset:512
    v_mfma_f32_16x16x32_bf16 v[60:63], v[156:159], v[120:123], v[60:63]
    ds_read_b64_tr_b16 v[164:165], v19 offset:0
    ds_read_b64_tr_b16 v[166:167], v19 offset:512
    v_mfma_f32_16x16x32_bf16 v[64:67], v[152:155], v[124:127], v[64:67]
    ds_read_b128 v[96:99], v12 offset:43008
    ds_read_b64_tr_b16 v[168:169], v18 offset:4096
    v_mfma_f32_16x16x32_bf16 v[68:71], v[156:159], v[124:127], v[68:71]
    ds_read_b64_tr_b16 v[170:171], v18 offset:4608
    ds_read_b64_tr_b16 v[172:173], v19 offset:4096
    v_mfma_f32_16x16x32_bf16 v[72:75], v[152:155], v[128:131], v[72:75]
    ds_read_b64_tr_b16 v[174:175], v19 offset:4608
    ds_read_b128 v[100:103], v14 offset:43008
    v_mfma_f32_16x16x32_bf16 v[76:79], v[156:159], v[128:131], v[76:79]
    ds_read_b64_tr_b16 v[176:177], v18 offset:8192
    ds_read_b64_tr_b16 v[178:179], v18 offset:8704
    v_mfma_f32_16x16x32_bf16 v[80:83], v[152:155], v[132:135], v[80:83]
    ds_read_b64_tr_b16 v[180:181], v19 offset:8192
    ds_read_b64_tr_b16 v[182:183], v19 offset:8704
    v_mfma_f32_16x16x32_bf16 v[84:87], v[156:159], v[132:135], v[84:87]
    ds_read_b128 v[104:107], v16 offset:43008
    v_mfma_f32_16x16x32_bf16 v[88:91], v[152:155], v[136:139], v[88:91]
    v_mfma_f32_16x16x32_bf16 v[92:95], v[156:159], v[136:139], v[92:95]
    s_waitcnt lgkmcnt(10)
    v_mfma_f32_16x16x32_bf16 v[56:59], v[160:163], v[96:99], v[56:59]
    ds_read_b64_tr_b16 v[184:185], v18 offset:12288
    ds_read_b64_tr_b16 v[186:187], v18 offset:12800
    v_mfma_f32_16x16x32_bf16 v[60:63], v[164:167], v[96:99], v[60:63]
    ds_read_b64_tr_b16 v[188:189], v19 offset:12288
    ds_read_b64_tr_b16 v[190:191], v19 offset:12800
    s_waitcnt lgkmcnt(9)
    v_mfma_f32_16x16x32_bf16 v[56:59], v[168:171], v[100:103], v[56:59]
    ds_read_b128 v[108:111], v13 offset:43008
    ds_read_b64_tr_b16 v[192:193], v18 offset:16384
    v_mfma_f32_16x16x32_bf16 v[60:63], v[172:175], v[100:103], v[60:63]
    ds_read_b64_tr_b16 v[194:195], v18 offset:16896
    ds_read_b64_tr_b16 v[196:197], v19 offset:16384
    s_waitcnt lgkmcnt(8)
    v_mfma_f32_16x16x32_bf16 v[56:59], v[176:179], v[104:107], v[56:59]
    ds_read_b64_tr_b16 v[198:199], v19 offset:16896
    ds_read_b128 v[112:115], v15 offset:43008
    v_mfma_f32_16x16x32_bf16 v[60:63], v[180:183], v[104:107], v[60:63]
    ds_read_b64_tr_b16 v[200:201], v18 offset:20480
    ds_read_b64_tr_b16 v[202:203], v18 offset:20992
    s_waitcnt lgkmcnt(7)
    v_mfma_f32_16x16x32_bf16 v[56:59], v[184:187], v[108:111], v[56:59]
    ds_read_b64_tr_b16 v[204:205], v19 offset:20480
    ds_read_b64_tr_b16 v[206:207], v19 offset:20992
    v_mfma_f32_16x16x32_bf16 v[60:63], v[188:191], v[108:111], v[60:63]
    ds_read_b128 v[116:119], v17 offset:43008
    ds_read_b128 v[120:123], v12 offset:45056
    s_waitcnt lgkmcnt(6)
    v_mfma_f32_16x16x32_bf16 v[56:59], v[192:195], v[112:115], v[56:59]
    ds_read_b128 v[124:127], v14 offset:45056
    ds_read_b128 v[128:131], v16 offset:45056
    v_mfma_f32_16x16x32_bf16 v[60:63], v[196:199], v[112:115], v[60:63]
    ds_read_b128 v[132:135], v13 offset:45056
    ds_read_b128 v[136:139], v15 offset:45056
    s_waitcnt lgkmcnt(5)
    v_mfma_f32_16x16x32_bf16 v[56:59], v[200:203], v[116:119], v[56:59]
    ds_read_b128 v[140:143], v17 offset:45056
    v_mfma_f32_16x16x32_bf16 v[60:63], v[204:207], v[116:119], v[60:63]
    s_waitcnt lgkmcnt(5)
    v_mfma_f32_16x16x32_bf16 v[64:67], v[160:163], v[120:123], v[64:67]
    ds_read_b128 v[96:99], v12 offset:47104
    v_mfma_f32_16x16x32_bf16 v[68:71], v[164:167], v[120:123], v[68:71]
    ds_read_b128 v[100:103], v14 offset:47104
    v_pk_fma_f32 v[208:209], v[56:57], v[22:23], v[30:31]
    v_pk_fma_f32 v[216:217], v[56:57], v[38:39], v[46:47]
    v_pk_fma_f32 v[210:211], v[58:59], v[24:25], v[32:33]
    s_waitcnt lgkmcnt(6)
    v_mfma_f32_16x16x32_bf16 v[64:67], v[168:171], v[124:127], v[64:67]
    ds_read_b128 v[104:107], v16 offset:47104
    v_pk_fma_f32 v[218:219], v[58:59], v[40:41], v[48:49]
    v_pk_fma_f32 v[212:213], v[60:61], v[26:27], v[34:35]
    v_pk_fma_f32 v[220:221], v[60:61], v[42:43], v[50:51]
    v_mfma_f32_16x16x32_bf16 v[68:71], v[172:175], v[124:127], v[68:71]
    ds_read_b128 v[108:111], v13 offset:47104
    v_pk_fma_f32 v[214:215], v[62:63], v[28:29], v[36:37]
    v_pk_fma_f32 v[222:223], v[62:63], v[44:45], v[52:53]
    v_exp_f32 v216, v216
    s_waitcnt lgkmcnt(7)
    v_mfma_f32_16x16x32_bf16 v[64:67], v[176:179], v[128:131], v[64:67]
    ds_read_b128 v[112:115], v15 offset:47104
    v_exp_f32 v217, v217
    v_exp_f32 v218, v218
    v_exp_f32 v219, v219
    v_mfma_f32_16x16x32_bf16 v[68:71], v[180:183], v[128:131], v[68:71]
    ds_read_b128 v[116:119], v17 offset:47104
    v_exp_f32 v220, v220
    v_exp_f32 v221, v221
    v_exp_f32 v222, v222
    s_waitcnt lgkmcnt(8)
    v_mfma_f32_16x16x32_bf16 v[64:67], v[184:187], v[132:135], v[64:67]
    v_exp_f32 v223, v223
    v_pk_add_f32 v[216:217], v[216:217], v[54:55]
    v_pk_add_f32 v[218:219], v[218:219], v[54:55]
    v_mfma_f32_16x16x32_bf16 v[68:71], v[188:191], v[132:135], v[68:71]
    v_pk_add_f32 v[220:221], v[220:221], v[54:55]
    v_pk_add_f32 v[222:223], v[222:223], v[54:55]
    v_rcp_f32 v216, v216
    s_waitcnt lgkmcnt(7)
    v_mfma_f32_16x16x32_bf16 v[64:67], v[192:195], v[136:139], v[64:67]
    v_rcp_f32 v217, v217
    v_rcp_f32 v218, v218
    v_rcp_f32 v219, v219
    v_mfma_f32_16x16x32_bf16 v[68:71], v[196:199], v[136:139], v[68:71]
    v_rcp_f32 v220, v220
    v_rcp_f32 v221, v221
    v_rcp_f32 v222, v222
    s_waitcnt lgkmcnt(6)
    v_mfma_f32_16x16x32_bf16 v[64:67], v[200:203], v[140:143], v[64:67]
    v_rcp_f32 v223, v223
    v_pk_mul_f32 v[208:209], v[208:209], v[216:217]
    v_pk_mul_f32 v[210:211], v[210:211], v[218:219]
    v_mfma_f32_16x16x32_bf16 v[68:71], v[204:207], v[140:143], v[68:71]
    v_pk_mul_f32 v[212:213], v[212:213], v[220:221]
    v_pk_mul_f32 v[214:215], v[214:215], v[222:223]
    v_cvt_pk_bf16_f32 v224, v208, v209
    s_waitcnt lgkmcnt(5)
    v_mfma_f32_16x16x32_bf16 v[72:75], v[160:163], v[96:99], v[72:75]
    ds_read_b128 v[120:123], v12 offset:49152
    v_mfma_f32_16x16x32_bf16 v[76:79], v[164:167], v[96:99], v[76:79]
    ds_read_b128 v[124:127], v14 offset:49152
    v_cvt_pk_bf16_f32 v225, v210, v211
    v_cvt_pk_bf16_f32 v226, v212, v213
    v_cvt_pk_bf16_f32 v227, v214, v215
    s_waitcnt lgkmcnt(6)
    v_mfma_f32_16x16x32_bf16 v[72:75], v[168:171], v[100:103], v[72:75]
    ds_read_b128 v[128:131], v16 offset:49152
    s_nop 1
    v_permlane16_swap_b32 v224, v226
    v_permlane16_swap_b32 v225, v227
    v_mfma_f32_16x16x32_bf16 v[76:79], v[172:175], v[100:103], v[76:79]
    ds_read_b128 v[132:135], v13 offset:49152
    s_mov_b32 s62, 0
    s_nop 0
    buffer_store_dwordx4 v[224:227], v10, s[28:31], s62 offen
    s_waitcnt lgkmcnt(7)
    v_mfma_f32_16x16x32_bf16 v[72:75], v[176:179], v[104:107], v[72:75]
    ds_read_b128 v[136:139], v15 offset:49152
    v_pk_fma_f32 v[208:209], v[64:65], v[22:23], v[30:31]
    v_pk_fma_f32 v[216:217], v[64:65], v[38:39], v[46:47]
    v_pk_fma_f32 v[210:211], v[66:67], v[24:25], v[32:33]
    v_mfma_f32_16x16x32_bf16 v[76:79], v[180:183], v[104:107], v[76:79]
    ds_read_b128 v[140:143], v17 offset:49152
    v_pk_fma_f32 v[218:219], v[66:67], v[40:41], v[48:49]
    v_pk_fma_f32 v[212:213], v[68:69], v[26:27], v[34:35]
    v_pk_fma_f32 v[220:221], v[68:69], v[42:43], v[50:51]
    s_waitcnt lgkmcnt(8)
    v_mfma_f32_16x16x32_bf16 v[72:75], v[184:187], v[108:111], v[72:75]
    v_pk_fma_f32 v[214:215], v[70:71], v[28:29], v[36:37]
    v_pk_fma_f32 v[222:223], v[70:71], v[44:45], v[52:53]
    v_exp_f32 v216, v216
    v_mfma_f32_16x16x32_bf16 v[76:79], v[188:191], v[108:111], v[76:79]
    v_exp_f32 v217, v217
    v_exp_f32 v218, v218
    v_exp_f32 v219, v219
    s_waitcnt lgkmcnt(7)
    v_mfma_f32_16x16x32_bf16 v[72:75], v[192:195], v[112:115], v[72:75]
    v_exp_f32 v220, v220
    v_exp_f32 v221, v221
    v_exp_f32 v222, v222
    v_mfma_f32_16x16x32_bf16 v[76:79], v[196:199], v[112:115], v[76:79]
    v_exp_f32 v223, v223
    v_pk_add_f32 v[216:217], v[216:217], v[54:55]
    v_pk_add_f32 v[218:219], v[218:219], v[54:55]
    s_waitcnt lgkmcnt(6)
    v_mfma_f32_16x16x32_bf16 v[72:75], v[200:203], v[116:119], v[72:75]
    v_pk_add_f32 v[220:221], v[220:221], v[54:55]
    v_pk_add_f32 v[222:223], v[222:223], v[54:55]
    v_rcp_f32 v216, v216
    v_mfma_f32_16x16x32_bf16 v[76:79], v[204:207], v[116:119], v[76:79]
    v_rcp_f32 v217, v217
    v_rcp_f32 v218, v218
    v_rcp_f32 v219, v219
    s_waitcnt lgkmcnt(5)
    v_mfma_f32_16x16x32_bf16 v[80:83], v[160:163], v[120:123], v[80:83]
    ds_read_b128 v[96:99], v12 offset:51200
    v_mfma_f32_16x16x32_bf16 v[84:87], v[164:167], v[120:123], v[84:87]
    ds_read_b128 v[100:103], v14 offset:51200
    v_rcp_f32 v220, v220
    v_rcp_f32 v221, v221
    v_rcp_f32 v222, v222
    s_waitcnt lgkmcnt(6)
    v_mfma_f32_16x16x32_bf16 v[80:83], v[168:171], v[124:127], v[80:83]
    ds_read_b128 v[104:107], v16 offset:51200
    v_rcp_f32 v223, v223
    v_pk_mul_f32 v[208:209], v[208:209], v[216:217]
    v_pk_mul_f32 v[210:211], v[210:211], v[218:219]
    v_mfma_f32_16x16x32_bf16 v[84:87], v[172:175], v[124:127], v[84:87]
    ds_read_b128 v[108:111], v13 offset:51200
    v_pk_mul_f32 v[212:213], v[212:213], v[220:221]
    v_pk_mul_f32 v[214:215], v[214:215], v[222:223]
    v_cvt_pk_bf16_f32 v228, v208, v209
    s_waitcnt lgkmcnt(7)
    v_mfma_f32_16x16x32_bf16 v[80:83], v[176:179], v[128:131], v[80:83]
    ds_read_b128 v[112:115], v15 offset:51200
    v_cvt_pk_bf16_f32 v229, v210, v211
    v_cvt_pk_bf16_f32 v230, v212, v213
    v_cvt_pk_bf16_f32 v231, v214, v215
    v_mfma_f32_16x16x32_bf16 v[84:87], v[180:183], v[128:131], v[84:87]
    ds_read_b128 v[116:119], v17 offset:51200
    s_nop 1
    v_permlane16_swap_b32 v228, v230
    v_permlane16_swap_b32 v229, v231
    s_waitcnt lgkmcnt(8)
    v_mfma_f32_16x16x32_bf16 v[80:83], v[184:187], v[132:135], v[80:83]
    s_mov_b32 s62, 18432
    s_nop 0
    buffer_store_dwordx4 v[228:231], v10, s[28:31], s62 offen
    v_mfma_f32_16x16x32_bf16 v[84:87], v[188:191], v[132:135], v[84:87]
    v_pk_fma_f32 v[208:209], v[72:73], v[22:23], v[30:31]
    v_pk_fma_f32 v[216:217], v[72:73], v[38:39], v[46:47]
    v_pk_fma_f32 v[210:211], v[74:75], v[24:25], v[32:33]
    s_waitcnt lgkmcnt(7)
    v_mfma_f32_16x16x32_bf16 v[80:83], v[192:195], v[136:139], v[80:83]
    v_pk_fma_f32 v[218:219], v[74:75], v[40:41], v[48:49]
    v_pk_fma_f32 v[212:213], v[76:77], v[26:27], v[34:35]
    v_pk_fma_f32 v[220:221], v[76:77], v[42:43], v[50:51]
    v_mfma_f32_16x16x32_bf16 v[84:87], v[196:199], v[136:139], v[84:87]
    v_pk_fma_f32 v[214:215], v[78:79], v[28:29], v[36:37]
    v_pk_fma_f32 v[222:223], v[78:79], v[44:45], v[52:53]
    v_exp_f32 v216, v216
    s_waitcnt lgkmcnt(6)
    v_mfma_f32_16x16x32_bf16 v[80:83], v[200:203], v[140:143], v[80:83]
    v_exp_f32 v217, v217
    v_exp_f32 v218, v218
    v_exp_f32 v219, v219
    v_mfma_f32_16x16x32_bf16 v[84:87], v[204:207], v[140:143], v[84:87]
    v_exp_f32 v220, v220
    v_exp_f32 v221, v221
    v_exp_f32 v222, v222
    s_waitcnt lgkmcnt(5)
    v_mfma_f32_16x16x32_bf16 v[88:91], v[160:163], v[96:99], v[88:91]
    v_mfma_f32_16x16x32_bf16 v[92:95], v[164:167], v[96:99], v[92:95]
    v_exp_f32 v223, v223
    v_pk_add_f32 v[216:217], v[216:217], v[54:55]
    v_pk_add_f32 v[218:219], v[218:219], v[54:55]
    s_waitcnt lgkmcnt(4)
    v_mfma_f32_16x16x32_bf16 v[88:91], v[168:171], v[100:103], v[88:91]
    v_pk_add_f32 v[220:221], v[220:221], v[54:55]
    v_pk_add_f32 v[222:223], v[222:223], v[54:55]
    v_rcp_f32 v216, v216
    v_mfma_f32_16x16x32_bf16 v[92:95], v[172:175], v[100:103], v[92:95]
    v_rcp_f32 v217, v217
    v_rcp_f32 v218, v218
    v_rcp_f32 v219, v219
    s_waitcnt lgkmcnt(3)
    v_mfma_f32_16x16x32_bf16 v[88:91], v[176:179], v[104:107], v[88:91]
    v_rcp_f32 v220, v220
    v_rcp_f32 v221, v221
    v_rcp_f32 v222, v222
    v_mfma_f32_16x16x32_bf16 v[92:95], v[180:183], v[104:107], v[92:95]
    v_rcp_f32 v223, v223
    v_pk_mul_f32 v[208:209], v[208:209], v[216:217]
    v_pk_mul_f32 v[210:211], v[210:211], v[218:219]
    s_waitcnt lgkmcnt(2)
    v_mfma_f32_16x16x32_bf16 v[88:91], v[184:187], v[108:111], v[88:91]
    v_pk_mul_f32 v[212:213], v[212:213], v[220:221]
    v_pk_mul_f32 v[214:215], v[214:215], v[222:223]
    v_cvt_pk_bf16_f32 v224, v208, v209
    v_mfma_f32_16x16x32_bf16 v[92:95], v[188:191], v[108:111], v[92:95]
    v_cvt_pk_bf16_f32 v225, v210, v211
    v_cvt_pk_bf16_f32 v226, v212, v213
    v_cvt_pk_bf16_f32 v227, v214, v215
    s_waitcnt lgkmcnt(1)
    v_mfma_f32_16x16x32_bf16 v[88:91], v[192:195], v[112:115], v[88:91]
    s_nop 1
    v_permlane16_swap_b32 v224, v226
    v_permlane16_swap_b32 v225, v227
    v_mfma_f32_16x16x32_bf16 v[92:95], v[196:199], v[112:115], v[92:95]
    s_mov_b32 s62, 36864
    s_nop 0
    buffer_store_dwordx4 v[224:227], v10, s[28:31], s62 offen
    s_waitcnt lgkmcnt(0)
    v_mfma_f32_16x16x32_bf16 v[88:91], v[200:203], v[116:119], v[88:91]
    v_pk_fma_f32 v[208:209], v[80:81], v[22:23], v[30:31]
    v_pk_fma_f32 v[216:217], v[80:81], v[38:39], v[46:47]
    v_pk_fma_f32 v[210:211], v[82:83], v[24:25], v[32:33]
    v_mfma_f32_16x16x32_bf16 v[92:95], v[204:207], v[116:119], v[92:95]
    v_pk_fma_f32 v[218:219], v[82:83], v[40:41], v[48:49]
    v_pk_fma_f32 v[212:213], v[84:85], v[26:27], v[34:35]
    v_pk_fma_f32 v[220:221], v[84:85], v[42:43], v[50:51]
    s_nop 7
    s_nop 1
    v_pk_fma_f32 v[214:215], v[86:87], v[28:29], v[36:37]
    v_pk_fma_f32 v[222:223], v[86:87], v[44:45], v[52:53]
    v_exp_f32 v216, v216
    v_exp_f32 v217, v217
    v_exp_f32 v218, v218
    v_exp_f32 v219, v219
    v_exp_f32 v220, v220
    v_exp_f32 v221, v221
    v_exp_f32 v222, v222
    v_exp_f32 v223, v223
    v_pk_add_f32 v[216:217], v[216:217], v[54:55]
    v_pk_add_f32 v[218:219], v[218:219], v[54:55]
    v_pk_add_f32 v[220:221], v[220:221], v[54:55]
    v_pk_add_f32 v[222:223], v[222:223], v[54:55]
    v_rcp_f32 v216, v216
    v_rcp_f32 v217, v217
    v_rcp_f32 v218, v218
    v_rcp_f32 v219, v219
    v_rcp_f32 v220, v220
    v_rcp_f32 v221, v221
    v_rcp_f32 v222, v222
    v_rcp_f32 v223, v223
    v_pk_mul_f32 v[208:209], v[208:209], v[216:217]
    v_pk_mul_f32 v[210:211], v[210:211], v[218:219]
    v_pk_mul_f32 v[212:213], v[212:213], v[220:221]
    v_pk_mul_f32 v[214:215], v[214:215], v[222:223]
    v_cvt_pk_bf16_f32 v228, v208, v209
    v_cvt_pk_bf16_f32 v229, v210, v211
    v_cvt_pk_bf16_f32 v230, v212, v213
    v_cvt_pk_bf16_f32 v231, v214, v215
    s_nop 1
    v_permlane16_swap_b32 v228, v230
    v_permlane16_swap_b32 v229, v231
    s_mov_b32 s62, 55296
    s_nop 0
    buffer_store_dwordx4 v[228:231], v10, s[28:31], s62 offen
    v_pk_fma_f32 v[208:209], v[88:89], v[22:23], v[30:31]
    v_pk_fma_f32 v[216:217], v[88:89], v[38:39], v[46:47]
    v_pk_fma_f32 v[210:211], v[90:91], v[24:25], v[32:33]
    v_pk_fma_f32 v[218:219], v[90:91], v[40:41], v[48:49]
    v_pk_fma_f32 v[212:213], v[92:93], v[26:27], v[34:35]
    v_pk_fma_f32 v[220:221], v[92:93], v[42:43], v[50:51]
    v_pk_fma_f32 v[214:215], v[94:95], v[28:29], v[36:37]
    v_pk_fma_f32 v[222:223], v[94:95], v[44:45], v[52:53]
    v_exp_f32 v216, v216
    v_exp_f32 v217, v217
    v_exp_f32 v218, v218
    v_exp_f32 v219, v219
    v_exp_f32 v220, v220
    v_exp_f32 v221, v221
    v_exp_f32 v222, v222
    v_exp_f32 v223, v223
    v_pk_add_f32 v[216:217], v[216:217], v[54:55]
    v_pk_add_f32 v[218:219], v[218:219], v[54:55]
    v_pk_add_f32 v[220:221], v[220:221], v[54:55]
    v_pk_add_f32 v[222:223], v[222:223], v[54:55]
    v_rcp_f32 v216, v216
    v_rcp_f32 v217, v217
    v_rcp_f32 v218, v218
    v_rcp_f32 v219, v219
    v_rcp_f32 v220, v220
    v_rcp_f32 v221, v221
    v_rcp_f32 v222, v222
    v_rcp_f32 v223, v223
    v_pk_mul_f32 v[208:209], v[208:209], v[216:217]
    v_pk_mul_f32 v[210:211], v[210:211], v[218:219]
    v_pk_mul_f32 v[212:213], v[212:213], v[220:221]
    v_pk_mul_f32 v[214:215], v[214:215], v[222:223]
    v_cvt_pk_bf16_f32 v224, v208, v209
    v_cvt_pk_bf16_f32 v225, v210, v211
    v_cvt_pk_bf16_f32 v226, v212, v213
    v_cvt_pk_bf16_f32 v227, v214, v215
    s_nop 1
    v_permlane16_swap_b32 v224, v226
    v_permlane16_swap_b32 v225, v227
    s_mov_b32 s62, 73728
    s_nop 0
    buffer_store_dwordx4 v[224:227], v10, s[28:31], s62 offen
    s_endpgm
L_loader:
    s_sub_u32 s65, s57, 4
    s_lshl_b32 s60, s65, 10
    s_and_b32 s64, s65, 1
    s_lshl_b32 s58, s65, 3
    s_sub_u32 s58, 128, s58
    s_mul_i32 s61, s58, 1152
    v_lshrrev_b32 v2, 3, v1
    v_lshrrev_b32 v3, 4, v1
    v_lshlrev_b32 v3, 1, v3
    v_and_b32 v4, 7, v1
    v_xor_b32 v4, v4, v3
    v_lshlrev_b32 v4, 4, v4
    s_sub_u32 s58, s55, 1
    s_lshl_b32 s59, s65, 3
    s_add_u32 s58, s58, s59
    v_add_u32 v5, s58, v2
    s_movk_i32 s59, 1152
    v_mul_lo_u32 v7, v5, s59
    v_add_u32 v7, v7, v4
    v_add_u32 v8, 32, v5
    v_mul_lo_u32 v8, v8, s59
    v_add_u32 v8, v8, v4
    v_cmp_gt_i32 vcc, 0, v5
    v_mov_b32 v6, 0x40000000
    s_nop 1
    v_cndmask_b32 v7, v7, v6, vcc
    s_lshl_b32 s58, s65, 3
    v_add_u32 v5, s58, v2
    v_mul_lo_u32 v9, v5, s59
    v_lshrrev_b32 v3, 4, v1
    v_and_b32 v3, 1, v3
    v_lshlrev_b32 v3, 1, v3
    s_lshl_b32 s58, s64, 2
    v_or_b32 v3, s58, v3
    v_and_b32 v4, 7, v1
    v_xor_b32 v4, v4, v3
    v_lshlrev_b32 v4, 4, v4
    v_add_u32 v9, v9, v4
    s_lshl_b32 s58, s56, 1
    v_add_u32 v9, s58, v9
    s_waitcnt lgkmcnt(0)
    s_mul_i32 s58, s53, 2359296
    s_add_u32 s20, s4, s58
    s_addc_u32 s21, s5, 0
    s_and_b32 s21, s21, 0xffff
    s_mov_b32 s22, 2359296
    s_mov_b32 s23, 0x00020000
    s_mov_b32 s24, s6
    s_and_b32 s25, s7, 0xffff
    s_mov_b32 s26, 1990656
    s_mov_b32 s27, 0x00020000
    s_add_u32 m0, s60, 0
    s_movk_i32 s62, 0
    buffer_load_dwordx4 v7, s[20:23], s62 offen lds
    s_add_u32 m0, s60, 4096
    s_mov_b32 s62, 0
    buffer_load_dwordx4 v8, s[20:23], s62 offen lds
    s_add_u32 m0, s60, 8192
    s_mov_b32 s62, 36864
    buffer_load_dwordx4 v8, s[20:23], s62 offen lds
    s_add_u32 m0, s60, 12288
    s_mov_b32 s62, 73728
    buffer_load_dwordx4 v8, s[20:23], s62 offen lds
    s_add_u32 m0, s60, 16384
    s_mov_b32 s62, 110592
    buffer_load_dwordx4 v8, s[20:23], s62 offen lds
    s_mov_b32 m0, 20480
    s_add_u32 s62, s61, 0
    s_mov_b64 exec, 0xffff
    buffer_load_dwordx4 v8, s[20:23], s62 offen lds
    s_mov_b64 exec, -1
    s_add_u32 m0, s60, 64512
    s_mov_b32 s62, 0
    buffer_load_dwordx4 v9, s[24:27], s62 offen lds
    s_add_u32 m0, s60, 68608
    s_mov_b32 s62, 663552
    buffer_load_dwordx4 v9, s[24:27], s62 offen lds
    s_add_u32 m0, s60, 72704
    s_mov_b32 s62, 1327104
    buffer_load_dwordx4 v9, s[24:27], s62 offen lds
    s_add_u32 m0, s60, 76800
    s_mov_b32 s62, 36864
    buffer_load_dwordx4 v9, s[24:27], s62 offen lds
    s_add_u32 m0, s60, 80896
    s_mov_b32 s62, 700416
    buffer_load_dwordx4 v9, s[24:27], s62 offen lds
    s_add_u32 m0, s60, 84992
    s_mov_b32 s62, 1363968
    buffer_load_dwordx4 v9, s[24:27], s62 offen lds
    s_add_u32 m0, s60, 21504
    s_movk_i32 s62, 128
    buffer_load_dwordx4 v7, s[20:23], s62 offen lds
    s_add_u32 m0, s60, 25600
    s_mov_b32 s62, 128
    buffer_load_dwordx4 v8, s[20:23], s62 offen lds
    s_add_u32 m0, s60, 29696
    s_mov_b32 s62, 36992
    buffer_load_dwordx4 v8, s[20:23], s62 offen lds
    s_add_u32 m0, s60, 33792
    s_mov_b32 s62, 73856
    buffer_load_dwordx4 v8, s[20:23], s62 offen lds
    s_add_u32 m0, s60, 37888
    s_mov_b32 s62, 110720
    buffer_load_dwordx4 v8, s[20:23], s62 offen lds
    s_mov_b32 m0, 41984
    s_add_u32 s62, s61, 128
    s_mov_b64 exec, 0xffff
    buffer_load_dwordx4 v8, s[20:23], s62 offen lds
    s_mov_b64 exec, -1
    s_add_u32 m0, s60, 89088
    s_mov_b32 s62, 73728
    buffer_load_dwordx4 v9, s[24:27], s62 offen lds
    s_add_u32 m0, s60, 93184
    s_mov_b32 s62, 737280
    buffer_load_dwordx4 v9, s[24:27], s62 offen lds
    s_add_u32 m0, s60, 97280
    s_mov_b32 s62, 1400832
    buffer_load_dwordx4 v9, s[24:27], s62 offen lds
    s_add_u32 m0, s60, 101376
    s_mov_b32 s62, 110592
    buffer_load_dwordx4 v9, s[24:27], s62 offen lds
    s_add_u32 m0, s60, 105472
    s_mov_b32 s62, 774144
    buffer_load_dwordx4 v9, s[24:27], s62 offen lds
    s_add_u32 m0, s60, 109568
    s_mov_b32 s62, 1437696
    buffer_load_dwordx4 v9, s[24:27], s62 offen lds
    s_waitcnt vmcnt(12)
    s_barrier
    s_add_u32 m0, s60, 43008
    s_movk_i32 s62, 256
    buffer_load_dwordx4 v7, s[20:23], s62 offen lds
    s_add_u32 m0, s60, 47104
    s_mov_b32 s62, 256
    buffer_load_dwordx4 v8, s[20:23], s62 offen lds
    s_add_u32 m0, s60, 51200
    s_mov_b32 s62, 37120
    buffer_load_dwordx4 v8, s[20:23], s62 offen lds
    s_add_u32 m0, s60, 55296
    s_mov_b32 s62, 73984
    buffer_load_dwordx4 v8, s[20:23], s62 offen lds
    s_add_u32 m0, s60, 59392
    s_mov_b32 s62, 110848
    buffer_load_dwordx4 v8, s[20:23], s62 offen lds
    s_mov_b32 m0, 63488
    s_add_u32 s62, s61, 256
    s_mov_b64 exec, 0xffff
    buffer_load_dwordx4 v8, s[20:23], s62 offen lds
    s_mov_b64 exec, -1
    s_add_u32 m0, s60, 113664
    s_mov_b32 s62, 147456
    buffer_load_dwordx4 v9, s[24:27], s62 offen lds
    s_add_u32 m0, s60, 117760
    s_mov_b32 s62, 811008
    buffer_load_dwordx4 v9, s[24:27], s62 offen lds
    s_add_u32 m0, s60, 121856
    s_mov_b32 s62, 1474560
    buffer_load_dwordx4 v9, s[24:27], s62 offen lds
    s_add_u32 m0, s60, 125952
    s_mov_b32 s62, 184320
    buffer_load_dwordx4 v9, s[24:27], s62 offen lds
    s_add_u32 m0, s60, 130048
    s_mov_b32 s62, 847872
    buffer_load_dwordx4 v9, s[24:27], s62 offen lds
    s_add_u32 m0, s60, 134144
    s_mov_b32 s62, 1511424
    buffer_load_dwordx4 v9, s[24:27], s62 offen lds
    s_add_u32 m0, s60, 138240
    s_mov_b32 s62, 221184
    buffer_load_dwordx4 v9, s[24:27], s62 offen lds
    s_add_u32 m0, s60, 142336
    s_mov_b32 s62, 884736
    buffer_load_dwordx4 v9, s[24:27], s62 offen lds
    s_add_u32 m0, s60, 146432
    s_mov_b32 s62, 1548288
    buffer_load_dwordx4 v9, s[24:27], s62 offen lds
    s_add_u32 m0, s60, 150528
    s_mov_b32 s62, 258048
    buffer_load_dwordx4 v9, s[24:27], s62 offen lds
    s_add_u32 m0, s60, 154624
    s_mov_b32 s62, 921600
    buffer_load_dwordx4 v9, s[24:27], s62 offen lds
    s_add_u32 m0, s60, 158720
    s_mov_b32 s62, 1585152
    buffer_load_dwordx4 v9, s[24:27], s62 offen lds
    s_waitcnt vmcnt(18)
    s_barrier
    s_add_u32 m0, s60, 0
    s_movk_i32 s62, 384
    buffer_load_dwordx4 v7, s[20:23], s62 offen lds
    s_add_u32 m0, s60, 4096
    s_mov_b32 s62, 384
    buffer_load_dwordx4 v8, s[20:23], s62 offen lds
    s_add_u32 m0, s60, 8192
    s_mov_b32 s62, 37248
    buffer_load_dwordx4 v8, s[20:23], s62 offen lds
    s_add_u32 m0, s60, 12288
    s_mov_b32 s62, 74112
    buffer_load_dwordx4 v8, s[20:23], s62 offen lds
    s_add_u32 m0, s60, 16384
    s_mov_b32 s62, 110976
    buffer_load_dwordx4 v8, s[20:23], s62 offen lds
    s_mov_b32 m0, 20480
    s_add_u32 s62, s61, 384
    s_mov_b64 exec, 0xffff
    buffer_load_dwordx4 v8, s[20:23], s62 offen lds
    s_mov_b64 exec, -1
    s_add_u32 m0, s60, 64512
    s_mov_b32 s62, 294912
    buffer_load_dwordx4 v9, s[24:27], s62 offen lds
    s_add_u32 m0, s60, 68608
    s_mov_b32 s62, 958464
    buffer_load_dwordx4 v9, s[24:27], s62 offen lds
    s_add_u32 m0, s60, 72704
    s_mov_b32 s62, 1622016
    buffer_load_dwordx4 v9, s[24:27], s62 offen lds
    s_add_u32 m0, s60, 76800
    s_mov_b32 s62, 331776
    buffer_load_dwordx4 v9, s[24:27], s62 offen lds
    s_add_u32 m0, s60, 80896
    s_mov_b32 s62, 995328
    buffer_load_dwordx4 v9, s[24:27], s62 offen lds
    s_add_u32 m0, s60, 84992
    s_mov_b32 s62, 1658880
    buffer_load_dwordx4 v9, s[24:27], s62 offen lds
    s_waitcnt vmcnt(18)
    s_barrier
    s_add_u32 m0, s60, 21504
    s_movk_i32 s62, 512
    buffer_load_dwordx4 v7, s[20:23], s62 offen lds
    s_add_u32 m0, s60, 25600
    s_mov_b32 s62, 512
    buffer_load_dwordx4 v8, s[20:23], s62 offen lds
    s_add_u32 m0, s60, 29696
    s_mov_b32 s62, 37376
    buffer_load_dwordx4 v8, s[20:23], s62 offen lds
    s_add_u32 m0, s60, 33792
    s_mov_b32 s62, 74240
    buffer_load_dwordx4 v8, s[20:23], s62 offen lds
    s_add_u32 m0, s60, 37888
    s_mov_b32 s62, 111104
    buffer_load_dwordx4 v8, s[20:23], s62 offen lds
    s_mov_b32 m0, 41984
    s_add_u32 s62, s61, 512
    s_mov_b64 exec, 0xffff
    buffer_load_dwordx4 v8, s[20:23], s62 offen lds
    s_mov_b64 exec, -1
    s_add_u32 m0, s60, 89088
    s_mov_b32 s62, 368640
    buffer_load_dwordx4 v9, s[24:27], s62 offen lds
    s_add_u32 m0, s60, 93184
    s_mov_b32 s62, 1032192
    buffer_load_dwordx4 v9, s[24:27], s62 offen lds
    s_add_u32 m0, s60, 97280
    s_mov_b32 s62, 1695744
    buffer_load_dwordx4 v9, s[24:27], s62 offen lds
    s_add_u32 m0, s60, 101376
    s_mov_b32 s62, 405504
    buffer_load_dwordx4 v9, s[24:27], s62 offen lds
    s_add_u32 m0, s60, 105472
    s_mov_b32 s62, 1069056
    buffer_load_dwordx4 v9, s[24:27], s62 offen lds
    s_add_u32 m0, s60, 109568
    s_mov_b32 s62, 1732608
    buffer_load_dwordx4 v9, s[24:27], s62 offen lds
    s_waitcnt vmcnt(18)
    s_barrier
    s_add_u32 m0, s60, 43008
    s_movk_i32 s62, 640
    buffer_load_dwordx4 v7, s[20:23], s62 offen lds
    s_add_u32 m0, s60, 47104
    s_mov_b32 s62, 640
    buffer_load_dwordx4 v8, s[20:23], s62 offen lds
    s_add_u32 m0, s60, 51200
    s_mov_b32 s62, 37504
    buffer_load_dwordx4 v8, s[20:23], s62 offen lds
    s_add_u32 m0, s60, 55296
    s_mov_b32 s62, 74368
    buffer_load_dwordx4 v8, s[20:23], s62 offen lds
    s_add_u32 m0, s60, 59392
    s_mov_b32 s62, 111232
    buffer_load_dwordx4 v8, s[20:23], s62 offen lds
    s_mov_b32 m0, 63488
    s_add_u32 s62, s61, 640
    s_mov_b64 exec, 0xffff
    buffer_load_dwordx4 v8, s[20:23], s62 offen lds
    s_mov_b64 exec, -1
    s_add_u32 m0, s60, 113664
    s_mov_b32 s62, 442368
    buffer_load_dwordx4 v9, s[24:27], s62 offen lds
    s_add_u32 m0, s60, 117760
    s_mov_b32 s62, 1105920
    buffer_load_dwordx4 v9, s[24:27], s62 offen lds
    s_add_u32 m0, s60, 121856
    s_mov_b32 s62, 1769472
    buffer_load_dwordx4 v9, s[24:27], s62 offen lds
    s_add_u32 m0, s60, 125952
    s_mov_b32 s62, 479232
    buffer_load_dwordx4 v9, s[24:27], s62 offen lds
    s_add_u32 m0, s60, 130048
    s_mov_b32 s62, 1142784
    buffer_load_dwordx4 v9, s[24:27], s62 offen lds
    s_add_u32 m0, s60, 134144
    s_mov_b32 s62, 1806336
    buffer_load_dwordx4 v9, s[24:27], s62 offen lds
    s_waitcnt vmcnt(18)
    s_barrier
    s_add_u32 m0, s60, 0
    s_movk_i32 s62, 768
    buffer_load_dwordx4 v7, s[20:23], s62 offen lds
    s_add_u32 m0, s60, 4096
    s_mov_b32 s62, 768
    buffer_load_dwordx4 v8, s[20:23], s62 offen lds
    s_add_u32 m0, s60, 8192
    s_mov_b32 s62, 37632
    buffer_load_dwordx4 v8, s[20:23], s62 offen lds
    s_add_u32 m0, s60, 12288
    s_mov_b32 s62, 74496
    buffer_load_dwordx4 v8, s[20:23], s62 offen lds
    s_add_u32 m0, s60, 16384
    s_mov_b32 s62, 111360
    buffer_load_dwordx4 v8, s[20:23], s62 offen lds
    s_mov_b32 m0, 20480
    s_add_u32 s62, s61, 768
    s_mov_b64 exec, 0xffff
    buffer_load_dwordx4 v8, s[20:23], s62 offen lds
    s_mov_b64 exec, -1
    s_add_u32 m0, s60, 138240
    s_mov_b32 s62, 516096
    buffer_load_dwordx4 v9, s[24:27], s62 offen lds
    s_add_u32 m0, s60, 142336
    s_mov_b32 s62, 1179648
    buffer_load_dwordx4 v9, s[24:27], s62 offen lds
    s_add_u32 m0, s60, 146432
    s_mov_b32 s62, 1843200
    buffer_load_dwordx4 v9, s[24:27], s62 offen lds
    s_add_u32 m0, s60, 150528
    s_mov_b32 s62, 552960
    buffer_load_dwordx4 v9, s[24:27], s62 offen lds
    s_add_u32 m0, s60, 154624
    s_mov_b32 s62, 1216512
    buffer_load_dwordx4 v9, s[24:27], s62 offen lds
    s_add_u32 m0, s60, 158720
    s_mov_b32 s62, 1880064
    buffer_load_dwordx4 v9, s[24:27], s62 offen lds
    s_waitcnt vmcnt(18)
    s_barrier
    s_add_u32 m0, s60, 21504
    s_movk_i32 s62, 896
    buffer_load_dwordx4 v7, s[20:23], s62 offen lds
    s_add_u32 m0, s60, 25600
    s_mov_b32 s62, 896
    buffer_load_dwordx4 v8, s[20:23], s62 offen lds
    s_add_u32 m0, s60, 29696
    s_mov_b32 s62, 37760
    buffer_load_dwordx4 v8, s[20:23], s62 offen lds
    s_add_u32 m0, s60, 33792
    s_mov_b32 s62, 74624
    buffer_load_dwordx4 v8, s[20:23], s62 offen lds
    s_add_u32 m0, s60, 37888
    s_mov_b32 s62, 111488
    buffer_load_dwordx4 v8, s[20:23], s62 offen lds
    s_mov_b32 m0, 41984
    s_add_u32 s62, s61, 896
    s_mov_b64 exec, 0xffff
    buffer_load_dwordx4 v8, s[20:23], s62 offen lds
    s_mov_b64 exec, -1
    s_add_u32 m0, s60, 64512
    s_mov_b32 s62, 589824
    buffer_load_dwordx4 v9, s[24:27], s62 offen lds
    s_add_u32 m0, s60, 68608
    s_mov_b32 s62, 1253376
    buffer_load_dwordx4 v9, s[24:27], s62 offen lds
    s_add_u32 m0, s60, 72704
    s_mov_b32 s62, 1916928
    buffer_load_dwordx4 v9, s[24:27], s62 offen lds
    s_add_u32 m0, s60, 76800
    s_mov_b32 s62, 626688
    buffer_load_dwordx4 v9, s[24:27], s62 offen lds
    s_add_u32 m0, s60, 80896
    s_mov_b32 s62, 1290240
    buffer_load_dwordx4 v9, s[24:27], s62 offen lds
    s_add_u32 m0, s60, 84992
    s_mov_b32 s62, 1953792
    buffer_load_dwordx4 v9, s[24:27], s62 offen lds
    s_waitcnt vmcnt(18)
    s_barrier
    s_add_u32 m0, s60, 43008
    s_movk_i32 s62, 1024
    buffer_load_dwordx4 v7, s[20:23], s62 offen lds
    s_add_u32 m0, s60, 47104
    s_mov_b32 s62, 1024
    buffer_load_dwordx4 v8, s[20:23], s62 offen lds
    s_add_u32 m0, s60, 51200
    s_mov_b32 s62, 37888
    buffer_load_dwordx4 v8, s[20:23], s62 offen lds
    s_add_u32 m0, s60, 55296
    s_mov_b32 s62, 74752
    buffer_load_dwordx4 v8, s[20:23], s62 offen lds
    s_add_u32 m0, s60, 59392
    s_mov_b32 s62, 111616
    buffer_load_dwordx4 v8, s[20:23], s62 offen lds
    s_mov_b32 m0, 63488
    s_add_u32 s62, s61, 1024
    s_mov_b64 exec, 0xffff
    buffer_load_dwordx4 v8, s[20:23], s62 offen lds
    s_mov_b64 exec, -1
    s_waitcnt vmcnt(12)
    s_barrier
    s_waitcnt vmcnt(0)
    s_barrier
L_end:
    s_endpgm

.section .rodata,"a"
.p2align 6
.amdhsa_kernel standalone__batchnorm__prompt_kernel
  .amdhsa_next_free_vgpr 232
  .amdhsa_next_free_sgpr 68
  .amdhsa_accum_offset 232
  .amdhsa_group_segment_fixed_size 0
  .amdhsa_kernarg_size 72
  .amdhsa_user_sgpr_count 2
  .amdhsa_user_sgpr_kernarg_segment_ptr 1
  .amdhsa_system_sgpr_workgroup_id_x 1
.end_amdhsa_kernel
```
